```python
import torch

def _softmax(x, axis=-1):
    return torch.softmax(x, dim=axis)
def _gelu(x):
    return torch.nn.functional.gelu(x, approximate="tanh")
def _silu(x):
    return torch.nn.functional.silu(x)
def _sigmoid(x):
    return torch.sigmoid(x)
def _layernorm(x, axis=-1, eps=1e-5):
    m = x.mean(dim=axis, keepdim=True)
    v = x.var(dim=axis, keepdim=True, unbiased=False)
    return (x - m) / torch.sqrt(v + eps)
def _scatter_add(tgt, idx, src, axis=0):
    return tgt.clone().index_add_(axis, idx, src)
def _segment_sum(src, seg, n):
    out = torch.zeros((n,) + src.shape[1:], dtype=src.dtype)
    return out.index_add_(0, seg, src)
def _pad(x, pw):
    flat = tuple(v for pair in reversed(pw) for v in pair)
    return torch.nn.functional.pad(x, flat)

kernel_name = 'sequential_preLN__linear_attn_block__moe_arch_mod__prompt'

def setup_inputs():

    _w = (lambda a: (lambda t: t.to(torch.bfloat16) if t.is_floating_point() else t)(torch.as_tensor(a)))
    def _A_setup():
        B, S, D = 1, 2048, 576
        return {
            "x": _w((lambda *s: torch.randn(*s, dtype=torch.bfloat16) * 0.05)(B, S, D)),
            "wqkv": _w((lambda *s: torch.randn(*s, dtype=torch.bfloat16) * 0.2)(D, 3 * D)),
            "wo": _w((lambda *s: torch.randn(*s, dtype=torch.bfloat16) * 0.2)(D, D)),
        }
    _A_in = _A_setup()

    def _B_setup():
        B, S, D, F, C = 1, 2048, 576, 4608, 2
        return {
            "x": _w((lambda *s: torch.randn(*s, dtype=torch.bfloat16) * 0.05)(B, S, D)),
            "w_r": _w((lambda *s: torch.randn(*s, dtype=torch.bfloat16) * 0.2)(D)),
            "w_gate": _w((lambda *s: torch.randn(*s, dtype=torch.bfloat16) * 0.2)(D, F)),
            "w_up": _w((lambda *s: torch.randn(*s, dtype=torch.bfloat16) * 0.2)(D, F)),
            "w_down": _w((lambda *s: torch.randn(*s, dtype=torch.bfloat16) * 0.2)(F, D)),
        }
    _B_in = _B_setup()

    return {
        "A_x": _A_in["x"],
        "A_wqkv": _A_in["wqkv"],
        "A_wo": _A_in["wo"],
        "B_x": _B_in["x"],
        "B_w_r": _B_in["w_r"],
        "B_w_gate": _B_in["w_gate"],
        "B_w_up": _B_in["w_up"],
        "B_w_down": _B_in["w_down"],
    }

def reference(A_x, A_wqkv, A_wo, B_x, B_w_r, B_w_gate, B_w_up, B_w_down):
    def _A_ref(x, wqkv, wo):
        B, S, D = x.shape
        H = 32; Dh = D // H
        qkv = (lambda x, *d: x.permute(*d))((x @ wqkv).reshape(B, S, 3, H, Dh), 2, 0, 3, 1, 4)
        q, k, v = qkv[0], qkv[1], qkv[2]
        phi = lambda t: torch.where(t > 0, t + 1, torch.exp(t)) + 1e-6
        pq, pk = phi(q), phi(k)
        kv = torch.einsum("bhsd,bhse->bhde", pk, v)
        z = torch.einsum("bhsd->bhd", pk)
        num = torch.einsum("bhqd,bhde->bhqe", pq, kv)
        den = torch.einsum("bhqd,bhd->bhq", pq, z)[..., None] + 1e-6
        o = num / den
        return (lambda x, *d: x.permute(*d))(o, 0, 2, 1, 3).reshape(B, S, D) @ wo

    def _B_ref(x, w_r, w_gate, w_up, w_down):
        B, S, D = x.shape
        C = 2
        r = x @ w_r
        idx = torch.argsort(-r, axis=-1)[:, :C]
        idx_e = (lambda x, n, axis: torch.repeat_interleave(x, n, dim=axis))(idx.reshape(B, C, 1), D, axis=2)
        x_sel = (lambda x, i, axis: torch.take_along_dim(x, i, dim=axis))(x, idx_e, axis=1)
        g = _silu(x_sel @ w_gate)
        u = x_sel @ w_up
        y = (g * u) @ w_down
        r_sel = _sigmoid((lambda x, i, axis: torch.take_along_dim(x, i, dim=axis))(r, idx, axis=1))
        y = y * r_sel.reshape(B, C, 1)
        b_off = (torch.arange(B) * S).reshape(B, 1)
        flat_idx = (idx + b_off).reshape(B * C)
        zero = (x * 0.0).reshape(B * S, D)
        upd = _scatter_add(zero, flat_idx, y.reshape(B * C, D), axis=0)
        return x + upd.reshape(B, S, D)

    x = A_x
    h = x + _A_ref(_layernorm(x, axis=-1), A_wqkv, A_wo)
    h2 = h + _B_ref(_layernorm(h, axis=-1), B_w_r, B_w_gate, B_w_up, B_w_down)
    return h2
```

```asm
; @launch grid=(256,1,1) block=(512,1,1) lds=163840
.amdgcn_target "amdgcn-amd-amdhsa--gfx950"
.text
.globl sequential_preLN__linear_attn_block__moe_arch_mod__prompt_kernel
.p2align 8
.type sequential_preLN__linear_attn_block__moe_arch_mod__prompt_kernel,@function
sequential_preLN__linear_attn_block__moe_arch_mod__prompt_kernel:
  s_load_dwordx16 s[4:19], s[0:1], 0
  s_load_dwordx4 s[20:23], s[0:1], 64
  s_load_dwordx2 s[24:25], s[0:1], 80
  v_lshrrev_b32 v2, 6, v0
  v_and_b32 v1, 63, v0
  s_cmp_ge_u32 s2, 256
  v_readfirstlane_b32 s3, v2
  s_cbranch_scc1 L_end
  s_and_b32 s26, s2, 7
  s_lshr_b32 s27, s2, 3
  s_lshr_b32 s45, s26, 1
  s_and_b32 s46, s2, 1
  v_and_b32 v13, 15, v1
  v_lshrrev_b32 v14, 4, v1
  s_and_b32 s54, s3, 3
  s_cmp_lt_u32 s27, 16
  s_cbranch_scc1 L_A
  s_sub_u32 s47, s27, 16
  s_mov_b32 s35, 0x20000
  s_cmp_lt_u32 s27, 24
  s_cbranch_scc1 L_W0
  s_cmp_lt_u32 s27, 28
  s_cbranch_scc1 L_X0
  s_cmp_gt_u32 s3, 1
  s_cbranch_scc1 L_R
  s_getpc_b64 s[40:41]
L_pc0:
  s_and_b32 s57, s27, 3
  s_lshl_b32 s57, s57, 1
  s_add_u32 s57, s57, s3
  s_mul_i32 s57, s57, 5120
  v_min_u32_e64 v2, 39, v1
  v_lshl_add_u32 v2, v2, 7, s57
  v_min_u32 v2, L_codeend-L_pc0-4, v2
  global_load_dword v6, v2, s[40:41]
  s_branch L_R
L_X0:
  v_lshrrev_b32 v7, 3, v1
  v_and_b32_e64 v3, 7, v1
  v_mul_u32_u24 v2, 1152, v7
  v_lshl_add_u32 v2, v3, 4, v2
  v_add_u32 v5, 9216, v2
  s_lshl_b32 s55, s45, 2
  s_add_u32 s55, s55, s47
  s_lshl_b32 s55, s55, 3
  s_add_u32 s55, s55, s3
  s_sub_u32 s55, s55, 64
  s_mul_i32 s56, s55, 18432
  s_movk_i32 s57, 128
  s_mov_b32 s34, 2359296
  s_waitcnt lgkmcnt(0)
  s_mov_b64 s[32:33], s[4:5]
  s_branch L_E0
L_W0:
  v_add_u32 v3, 64, v1
  v_min_u32 v3, 119, v3
  v_mul_u32_u24 v4, 1639, v1
  v_lshrrev_b32 v4, 16, v4
  v_lshlrev_b32 v2, 4, v1
  v_lshl_add_u32 v2, v4, 9, v2
  v_mul_u32_u24 v4, 1639, v3
  v_lshrrev_b32 v4, 16, v4
  v_lshlrev_b32 v5, 4, v3
  v_lshl_add_u32 v5, v4, 9, v5
  s_lshl_b32 s56, s47, 3
  s_add_u32 s56, s56, s3
  s_mul_i32 s56, s56, 3456
  s_lshl_b32 s57, s46, 9
  s_add_u32 s56, s56, s57
  s_mov_b32 s57, 221184
  s_mov_b32 s34, 1990656
  s_waitcnt lgkmcnt(0)
  s_mov_b64 s[32:33], s[6:7]
L_E0:
  buffer_load_dwordx4 v[16:19], v2, s[32:35], s56 offen
  buffer_load_dwordx4 v[20:23], v5, s[32:35], s56 offen
  s_add_u32 s56, s56, s57
  s_barrier
  buffer_load_dwordx4 v[24:27], v2, s[32:35], s56 offen
  buffer_load_dwordx4 v[28:31], v5, s[32:35], s56 offen
  s_add_u32 s56, s56, s57
  s_branch L_B
L_A:
  s_and_b32 s47, s27, 7
  s_lshl_b32 s48, s46, 3
  s_add_u32 s48, s48, s47
  s_lshr_b32 s49, s27, 3
  s_lshl_b32 s50, s45, 1
  s_add_u32 s50, s50, s49
  s_lshr_b32 s51, s48, 1
  s_mul_i32 s51, s51, 144
  s_and_b32 s47, s27, 1
  s_lshl_b32 s52, s47, 3
  s_mov_b32 s53, s27
  s_cmp_lt_u32 s3, 4
  s_cbranch_scc1 L_compute
  s_setprio 2
  s_lshl_b32 s55, s50, 5
  s_add_u32 s55, s55, s54
  s_lshl_b32 s55, s55, 3
  v_lshrrev_b32 v2, 3, v1
  v_add_u32 v2, s55, v2
  v_mul_u32_u24 v16, 1152, v2
  s_and_b32 s56, s54, 1
  s_lshl_b32 s57, s56, 2
  v_add_u32 v3, s57, v14
  v_and_b32 v2, 7, v1
  v_xor_b32_e64 v2, v2, v3
  v_lshl_add_u32 v16, v2, 4, v16
  v_lshrrev_b32 v2, 1, v13
  v_xor_b32 v2, v2, v3
  v_and_b32_e64 v3, 1, v1
  v_lshl_add_u32 v2, v2, 1, v3
  v_min_u32 v2, 14, v2
  v_mul_u32_u24 v3, 52, v2
  v_lshrrev_b32 v3, 8, v3
  v_lshlrev_b32 v2, 4, v2
  v_and_b32 v4, 1, v3
  v_xor_b32 v4, s47, v4
  v_lshl_add_u32 v2, v4, 6, v2
  v_xor_b32 v15, 1, v3
  v_lshrrev_b32 v4, 1, v3
  v_sub_u32_e64 v15, v15, v4
  v_mul_u32_u24 v15, 1152, v15
  v_mul_u32_u24 v3, 80, v3
  v_sub_u32 v2, v2, v3
  s_lshl_b32 s55, s54, 3
  v_add_u32_e64 v3, s55, v14
  v_mul_u32_u24 v3, 3456, v3
  v_add3_u32 v17, v2, v3, v15
  s_lshl_b32 s41, s54, 10
  s_mov_b32 s55, 0
  s_mov_b32 s56, s51
  s_mov_b32 s43, 0
  s_mov_b32 s44, -1
  s_nop 0
  s_mov_b32 s30, 2359296
  s_mov_b32 s31, 0x20000
  s_mov_b32 s34, 1990656
  s_mov_b32 s35, 0x20000
  s_waitcnt lgkmcnt(0)
  s_mov_b32 s28, s4
  s_mov_b32 s29, s5
  s_mov_b32 s32, s6
  s_mov_b32 s33, s7
  s_mov_b32 s10, s55
  s_add_u32 m0, s41, 32768
  s_add_u32 s11, s56, 0
  buffer_load_dwordx4 v17, s[32:35], s11 offen  lds
  s_add_u32 m0, s41, 0
  s_nop 0
  s_nop 0
  buffer_load_dwordx4 v16, s[28:31], s10 offen  lds
  s_add_u32 m0, s41, 4096
  s_add_u32 s10, s10, 36864
  buffer_load_dwordx4 v16, s[28:31], s10 offen  lds
  s_add_u32 m0, s41, 36864
  s_add_u32 s11, s56, 13824
  buffer_load_dwordx4 v17, s[32:35], s11 offen  lds
  s_add_u32 m0, s41, 8192
  s_add_u32 s10, s10, 36864
  buffer_load_dwordx4 v16, s[28:31], s10 offen  lds
  s_add_u32 m0, s41, 12288
  s_add_u32 s10, s10, 36864
  buffer_load_dwordx4 v16, s[28:31], s10 offen  lds
  s_add_u32 m0, s41, 40960
  s_add_u32 s11, s56, 110592
  buffer_load_dwordx4 v17, s[32:35], s11 offen  lds
  s_add_u32 m0, s41, 16384
  s_add_u32 s10, s10, 36864
  buffer_load_dwordx4 v16, s[28:31], s10 offen  lds
  s_add_u32 m0, s41, 20480
  s_add_u32 s10, s10, 36864
  buffer_load_dwordx4 v16, s[28:31], s10 offen  lds
  v_lshl_add_u32 v2, s54, 6, v1
  s_lshl_b32 s57, s50, 10
  s_lshl_b32 s60, s46, 14
  s_add_u32 s60, s60, s57
  s_add_u32 s60, s60, 4194304
  v_lshlrev_b32 v18, 2, v2
  v_min_u32 v3, 107, v2
  v_mul_u32_u24 v4, 1821, v3
  v_lshrrev_b32 v4, 16, v4
  v_xor_b32 v5, 1, v4
  v_lshrrev_b32 v6, 1, v4
  v_sub_u32 v5, v5, v6
  v_mul_u32_u24 v5, 320, v5
  v_and_b32 v6, 1, v4
  v_xor_b32 v6, s47, v6
  v_mad_u32_u24 v5, v6, 36, v5
  v_mul_u32_u24 v4, 36, v4
  v_sub_u32 v3, v3, v4
  v_add_u32 v3, v3, v5
  v_lshlrev_b32_e64 v19, 2, v3
  s_lshl_b32 s61, s51, 1
  s_lshl_b32 s57, s46, 10
  s_sub_u32 s61, s61, s57
  s_mul_i32 s57, s26, 30720
  s_add_u32 s61, s61, s57
  s_add_u32 s61, s61, 4227072
  v_mov_b32 v28, 0
  s_mov_b32 s36, s24
  s_mov_b32 s37, s25
  s_mov_b32 s38, 268435456
  s_mov_b32 s39, 0x20000
  s_mov_b32 s64, s22
  s_mov_b32 s65, s23
  s_mov_b32 s66, 256
  s_add_u32 m0, s41, 45056
  s_add_u32 s11, s56, 124416
  buffer_load_dwordx4 v17, s[32:35], s11 offen  lds
  s_add_u32 m0, s41, 24576
  s_add_u32 s10, s10, 36864
  buffer_load_dwordx4 v16, s[28:31], s10 offen  lds
  s_mov_b32 s67, 0x20000
  v_add_u32 v40, 147456, v18
  v_lshlrev_b32 v25, 2, v18
  v_lshlrev_b32 v26, 1, v18
  v_add_u32 v26, 156672, v26
  s_xor_b32 s62, s48, 1
  s_mul_i32 s62, s62, 24576
  s_lshl_b32 s52, s48, 3
  s_add_u32 s52, s52, s50
  s_mul_i32 s52, s52, 3072
  s_cmp_ge_u32 s53, 9
  s_cselect_b32 s57, 9, 0
  s_sub_u32 s63, s53, s57
  v_lshrrev_b32 v2, 3, v1
  v_and_b32 v3, 7, v1
  v_bfe_u32 v4, v1, 4, 2
  v_lshlrev_b32 v4, 1, v4
  v_xor_b32 v3, v3, v4
  v_lshlrev_b32 v3, 4, v3
  s_lshl_b32 s57, s63, 7
  v_add_u32 v3, s57, v3
  v_lshrrev_b32 v4, 2, v2
  v_and_b32_e64 v5, 3, v2
  v_mad_u32_u24 v6, v4, 10, v5
  s_and_b32 s57, s54, 1
  s_mul_i32 s58, s57, 18
  s_lshr_b32 s59, s54, 1
  s_lshl_b32 s42, s59, 2
  s_add_u32 s58, s58, s42
  v_add_u32 v6, s58, v6
  v_mul_u32_u24 v6, 1152, v6
  v_add_u32_e64 v20, v6, v3
  v_mul_u32_u24 v4, 72, v4
  v_bfe_u32 v5, v2, 1, 1
  v_mad_u32_u24 v4, v5, 18, v4
  s_add_u32 m0, s41, 28672
  s_add_u32 s10, s10, 36864
  buffer_load_dwordx4 v16, s[28:31], s10 offen  lds
  v_and_b32 v5, 1, v2
  v_add_u32 v4, v4, v5
  s_mul_i32 s57, s57, 144
  s_mul_i32 s59, s59, 36
  s_add_u32 s57, s57, s59
  s_add_u32 s57, s57, 8
  v_add_u32 v4, s57, v4
  v_mul_u32_u24 v4, 1152, v4
  v_add_u32 v21, v4, v3
  v_and_b32 v3, 7, v1
  v_xor_b32_e64 v3, v3, v2
  v_mul_u32_u24 v4, 1152, v2
  v_lshl_add_u32 v29, v3, 4, v4
  s_cmp_ge_u32 s53, 9
  s_cselect_b32 s57, 16, 0
  s_lshl_b32 s49, s26, 5
  s_add_u32 s49, s49, s57
  s_add_u32 s49, s49, s54
  s_mul_i32 s49, s49, 9216
  s_lshl_b32 s57, s63, 7
  s_add_u32 s49, s49, s57
  s_mul_i32 s58, s3, 4608
  s_add_u32 s58, s58, 73728
  s_cmp_ge_u32 s53, 9
  s_cselect_b32 s59, 8, 0
  s_lshl_b32 s57, s26, 4
  s_add_u32 s59, s59, s57
  s_add_u32 s59, s59, s3
  v_lshlrev_b32 v249, 4, v13
  v_lshrrev_b32 v252, 3, v1
  v_lshrrev_b32_e64 v2, 2, v13
  v_lshl_add_u32 v2, v14, 2, v2
  v_bfe_u32 v3, v2, 1, 2
  v_lshlrev_b32_e64 v2, 7, v2
  s_add_u32 s55, s55, 128
  s_add_u32 s56, s56, 221184
  s_add_u32 s43, s43, 1
  s_add_u32 s41, s41, 49152
  s_cmp_eq_u32 s43, 3
  s_cselect_b32 s10, 147456, 0
  s_cselect_b32 s43, 0, s43
  s_sub_u32 s41, s41, s10
  s_add_u32 s44, s44, 1
  s_mov_b32 s10, s55
  s_add_u32 m0, s41, 32768
  s_add_u32 s11, s56, 0
  buffer_load_dwordx4 v17, s[32:35], s11 offen  lds
  s_add_u32 m0, s41, 0
  s_nop 0
  buffer_load_dwordx4 v16, s[28:31], s10 offen  lds
  v_and_b32 v4, 3, v13
  v_lshl_add_u32 v2, v4, 3, v2
  v_lshl_add_u32 v236, v3, 5, v2
  v_xor_b32 v237, 32, v236
  v_xor_b32 v238, 64, v236
  s_add_u32 m0, s41, 4096
  s_add_u32 s10, s10, 36864
  buffer_load_dwordx4 v16, s[28:31], s10 offen  lds
  v_xor_b32 v239, 96, v236
  s_lshl_b32 s57, s63, 7
  s_add_u32 s57, s57, 158272
  v_lshl_add_u32 v113, v14, 3, s57
  v_lshrrev_b32 v2, 1, v14
  s_add_u32 m0, s41, 36864
  s_add_u32 s11, s56, 13824
  buffer_load_dwordx4 v17, s[32:35], s11 offen  lds
  s_add_u32 m0, s41, 8192
  s_add_u32 s10, s10, 36864
  buffer_load_dwordx4 v16, s[28:31], s10 offen  lds
  v_and_b32 v3, 7, v13
  v_xor_b32 v2, v2, v3
  v_lshlrev_b32_e64 v2, 4, v2
  v_lshl_add_u32 v2, v13, 7, v2
  v_and_b32_e64 v3, 1, v14
  s_add_u32 m0, s41, 12288
  s_add_u32 s10, s10, 36864
  buffer_load_dwordx4 v16, s[28:31], s10 offen  lds
  v_lshl_add_u32 v2, v3, 3, v2
  s_lshl_b32 s57, s3, 11
  s_add_u32 s57, s57, 137216
  v_add_u32 v112, s57, v2
  v_and_b32_e64 v2, 3, v13
  s_add_u32 m0, s41, 40960
  s_add_u32 s11, s56, 110592
  buffer_load_dwordx4 v17, s[32:35], s11 offen  lds
  s_add_u32 m0, s41, 16384
  s_add_u32 s10, s10, 36864
  buffer_load_dwordx4 v16, s[28:31], s10 offen  lds
  v_cmp_eq_u32 s[68:69], 2, v2
  s_nop 1
  s_nop 0
  v_cndmask_b32_e64 v114, 0, -1, s[68:69]
  v_mov_b32 v4, 0x3f803f80
  v_cmp_eq_u32 s[68:69], 0, v2
  s_nop 1
  s_nop 0
  v_cndmask_b32_e64 v115, 0, v4, s[68:69]
  s_add_u32 m0, s41, 20480
  s_add_u32 s10, s10, 36864
  buffer_load_dwordx4 v16, s[28:31], s10 offen  lds
  v_mul_u32_u24 v250, 144, v13
  v_lshl_add_u32 v250, v14, 3, v250
  v_add_u32 v250, s58, v250
  v_add_u32 v251, v252, v1
  v_lshl_add_u32 v251, v251, 4, s58
  s_add_u32 m0, s41, 45056
  s_add_u32 s11, s56, 124416
  buffer_load_dwordx4 v17, s[32:35], s11 offen  lds
  s_add_u32 m0, s41, 24576
  s_add_u32 s10, s10, 36864
  buffer_load_dwordx4 v16, s[28:31], s10 offen  lds
  v_mul_u32_u24 v252, 1152, v252
  v_and_b32_e64 v253, 7, v1
  v_lshl_add_u32 v252, v253, 4, v252
  v_lshl_add_u32 v254, s59, 4, v13
  v_sub_u32 v254, 2047, v254
  s_add_u32 m0, s41, 28672
  s_add_u32 s10, s10, 36864
  buffer_load_dwordx4 v16, s[28:31], s10 offen  lds
  s_lshl_b32 s57, s3, 3
  s_add_u32 s57, s57, 159552
  v_mov_b32 v11, s57
  v_lshlrev_b32_e64 v5, 2, v13
  v_add_u32 v5, 159552, v5
  s_add_u32 s55, s55, 128
  s_add_u32 s56, s56, 221184
  s_add_u32 s43, s43, 1
  s_add_u32 s41, s41, 49152
  s_cmp_eq_u32 s43, 3
  s_cselect_b32 s10, 147456, 0
  s_cselect_b32 s43, 0, s43
  s_sub_u32 s41, s41, s10
  s_add_u32 s44, s44, 1
  s_setprio 1
L_hloop1:
  s_waitcnt vmcnt(12)
  s_barrier
  s_mov_b32 s10, s55
  s_add_u32 m0, s41, 32768
  s_add_u32 s11, s56, 0
  buffer_load_dwordx4 v17, s[32:35], s11 offen  lds
  s_add_u32 m0, s41, 0
  s_nop 0
  buffer_load_dwordx4 v16, s[28:31], s10 offen  lds
  s_add_u32 m0, s41, 4096
  s_add_u32 s10, s10, 36864
  buffer_load_dwordx4 v16, s[28:31], s10 offen  lds
  s_add_u32 m0, s41, 36864
  s_add_u32 s11, s56, 13824
  buffer_load_dwordx4 v17, s[32:35], s11 offen  lds
  s_add_u32 m0, s41, 8192
  s_add_u32 s10, s10, 36864
  buffer_load_dwordx4 v16, s[28:31], s10 offen  lds
  s_add_u32 m0, s41, 12288
  s_add_u32 s10, s10, 36864
  buffer_load_dwordx4 v16, s[28:31], s10 offen  lds
  s_add_u32 m0, s41, 40960
  s_add_u32 s11, s56, 110592
  buffer_load_dwordx4 v17, s[32:35], s11 offen  lds
  s_add_u32 m0, s41, 16384
  s_add_u32 s10, s10, 36864
  buffer_load_dwordx4 v16, s[28:31], s10 offen  lds
  s_add_u32 m0, s41, 20480
  s_add_u32 s10, s10, 36864
  buffer_load_dwordx4 v16, s[28:31], s10 offen  lds
  s_add_u32 m0, s41, 45056
  s_add_u32 s11, s56, 124416
  buffer_load_dwordx4 v17, s[32:35], s11 offen  lds
  s_add_u32 m0, s41, 24576
  s_add_u32 s10, s10, 36864
  buffer_load_dwordx4 v16, s[28:31], s10 offen  lds
  s_add_u32 m0, s41, 28672
  s_add_u32 s10, s10, 36864
  buffer_load_dwordx4 v16, s[28:31], s10 offen  lds
  s_add_u32 s55, s55, 128
  s_add_u32 s56, s56, 221184
  s_add_u32 s43, s43, 1
  s_add_u32 s41, s41, 49152
  s_cmp_eq_u32 s43, 3
  s_cselect_b32 s10, 147456, 0
  s_cselect_b32 s43, 0, s43
  s_sub_u32 s41, s41, s10
  s_add_u32 s44, s44, 1
  s_cmp_lg_u32 s44, 7
  s_cbranch_scc1 L_hloop1
  s_waitcnt vmcnt(12)
  s_barrier
  buffer_load_dword v27, v28, s[64:67], 0 offen offset:128 sc1
  s_mov_b32 s10, s55
  s_add_u32 m0, s41, 32768
  s_add_u32 s11, s56, 0
  buffer_load_dwordx4 v17, s[32:35], s11 offen  lds
  s_add_u32 m0, s41, 0
  s_nop 0
  s_nop 0
  buffer_load_dwordx4 v16, s[28:31], s10 offen  lds
  s_add_u32 m0, s41, 4096
  s_add_u32 s10, s10, 36864
  buffer_load_dwordx4 v16, s[28:31], s10 offen  lds
  s_add_u32 m0, s41, 36864
  s_add_u32 s11, s56, 13824
  buffer_load_dwordx4 v17, s[32:35], s11 offen  lds
  s_add_u32 m0, s41, 8192
  s_add_u32 s10, s10, 36864
  buffer_load_dwordx4 v16, s[28:31], s10 offen  lds
  s_add_u32 m0, s41, 12288
  s_add_u32 s10, s10, 36864
  buffer_load_dwordx4 v16, s[28:31], s10 offen  lds
  s_add_u32 m0, s41, 40960
  s_add_u32 s11, s56, 110592
  buffer_load_dwordx4 v17, s[32:35], s11 offen  lds
  s_add_u32 m0, s41, 16384
  s_add_u32 s10, s10, 36864
  buffer_load_dwordx4 v16, s[28:31], s10 offen  lds
  s_add_u32 m0, s41, 20480
  s_add_u32 s10, s10, 36864
  buffer_load_dwordx4 v16, s[28:31], s10 offen  lds
  s_add_u32 m0, s41, 45056
  s_add_u32 s11, s56, 124416
  buffer_load_dwordx4 v17, s[32:35], s11 offen  lds
  s_add_u32 m0, s41, 24576
  s_add_u32 s10, s10, 36864
  buffer_load_dwordx4 v16, s[28:31], s10 offen  lds
  s_add_u32 m0, s41, 28672
  s_add_u32 s10, s10, 36864
  buffer_load_dwordx4 v16, s[28:31], s10 offen  lds
  s_add_u32 s55, s55, 128
  s_add_u32 s56, s56, 221184
  s_add_u32 s43, s43, 1
  s_add_u32 s41, s41, 49152
  s_cmp_eq_u32 s43, 3
  s_cselect_b32 s10, 147456, 0
  s_cselect_b32 s43, 0, s43
  s_sub_u32 s41, s41, s10
  s_add_u32 s44, s44, 1
  s_waitcnt vmcnt(12)
  s_barrier
  v_cmp_eq_u32 vcc, 0, v27
  s_cbranch_vccz L_fok
  s_mov_b32 s59, 0
L_fl0a:
  buffer_load_dword v27, v28, s[64:67], 0 offen offset:128 sc1
L_fl1a:
  s_waitcnt vmcnt(0)
  v_cmp_eq_u32 vcc, 0, v27
  s_cbranch_vccz L_fl2a
  s_add_u32 s59, s59, 1
  s_cmp_lt_u32 s59, 131072
  s_cbranch_scc1 L_fl0a
L_fl2a:
L_fok:
  s_nop 0
  buffer_load_dword v30, v18, s[36:39], s60 offen sc1
  s_add_u32 s57, s60, 8192
  buffer_load_dword v31, v18, s[36:39], s57 offen sc1
  s_mov_b32 s57, s61
  s_nop 0
  buffer_load_dword v32, v19, s[36:39], s57 offen sc1
  s_add_u32 s57, s57, 3840
  buffer_load_dword v33, v19, s[36:39], s57 offen sc1
  s_add_u32 s57, s57, 3840
  buffer_load_dword v34, v19, s[36:39], s57 offen sc1
  s_add_u32 s57, s57, 3840
  buffer_load_dword v35, v19, s[36:39], s57 offen sc1
  s_add_u32 s57, s57, 3840
  buffer_load_dword v36, v19, s[36:39], s57 offen sc1
  s_add_u32 s57, s57, 3840
  buffer_load_dword v37, v19, s[36:39], s57 offen sc1
  s_add_u32 s57, s57, 3840
  buffer_load_dword v38, v19, s[36:39], s57 offen sc1
  s_add_u32 s57, s57, 3840
  buffer_load_dword v39, v19, s[36:39], s57 offen sc1
  buffer_load_dword v27, v28, s[64:67], 0 offen offset:132 sc1
  ds_read_b32 v22, v40
  ds_read_b32 v23, v40 offset:1024
  ds_read_b32 v24, v40 offset:2048
  ds_read_b32 v12, v40 offset:3072
  s_mov_b32 s68, s8
  s_mov_b32 s69, s9
  s_mov_b32 s70, 663552
  s_mov_b32 s71, 0x20000
  s_lshl_b32 s42, s54, 10
  s_mul_i32 s40, s63, 0
  s_and_b32 s40, s40, 15
  s_mul_i32 s40, s40, 41472
L_woda:
  s_mov_b32 m0, s42
  s_add_u32 s42, s42, 4096
  buffer_load_dwordx4 v20, s[68:71], s40 offen lds
  s_add_u32 s40, s40, 41472
  s_cmp_eq_u32 s40, 663552
  s_cselect_b32 s40, 0, s40
  s_cmp_lt_u32 s42, 16384
  s_cbranch_scc1 L_woda
  s_waitcnt vmcnt(15)
  s_barrier
  s_mov_b32 s59, 0
  s_waitcnt vmcnt(4)
  s_branch L_st1
L_st0:
  s_nop 0
  buffer_load_dword v30, v18, s[36:39], s60 offen sc1
  s_add_u32 s57, s60, 8192
  buffer_load_dword v31, v18, s[36:39], s57 offen sc1
  s_mov_b32 s57, s61
  s_nop 0
  buffer_load_dword v32, v19, s[36:39], s57 offen sc1
  s_add_u32 s57, s57, 3840
  buffer_load_dword v33, v19, s[36:39], s57 offen sc1
  s_add_u32 s57, s57, 3840
  buffer_load_dword v34, v19, s[36:39], s57 offen sc1
  s_add_u32 s57, s57, 3840
  buffer_load_dword v35, v19, s[36:39], s57 offen sc1
  s_add_u32 s57, s57, 3840
  buffer_load_dword v36, v19, s[36:39], s57 offen sc1
  s_add_u32 s57, s57, 3840
  buffer_load_dword v37, v19, s[36:39], s57 offen sc1
  s_add_u32 s57, s57, 3840
  buffer_load_dword v38, v19, s[36:39], s57 offen sc1
  s_add_u32 s57, s57, 3840
  buffer_load_dword v39, v19, s[36:39], s57 offen sc1
  s_waitcnt vmcnt(0)
L_st1:
  s_nop 0
  v_max3_u32 v2, v30, v31, v32
  v_max3_u32 v2, v2, v33, v34
  v_max3_u32 v2, v2, v35, v36
  v_max3_u32 v2, v2, v37, v38
  v_max_u32 v2, v2, v39
  v_cmp_eq_u32 vcc, -1, v2
  s_cbranch_vccz L_st2
  s_add_u32 s59, s59, 1
  s_cmp_lt_u32 s59, 131072
  s_cbranch_scc1 L_st0
L_st2:
  v_add_u32 v18, 153600, v18
  v_add_f32 v32, v32, v36
  v_add_f32 v33, v33, v37
  v_add_f32 v34, v34, v38
  v_add_f32 v35, v35, v39
  v_add_f32 v32, v32, v34
  v_add_f32 v33, v33, v35
  v_add_f32 v32, v32, v33
  ds_write_b32 v18, v30
  ds_write_b32 v18, v31 offset:1024
  ds_write_b32 v18, v32 offset:2048
L_woda2:
  s_mov_b32 m0, s42
  s_nop 0
  s_add_u32 s42, s42, 4096
  buffer_load_dwordx4 v20, s[68:71], s40 offen lds
  s_add_u32 s40, s40, 41472
  s_cmp_eq_u32 s40, 663552
  s_cselect_b32 s40, 0, s40
  s_cmp_lt_u32 s42, 32768
  s_cbranch_scc1 L_woda2
  s_waitcnt lgkmcnt(0)
  s_barrier
  s_setprio 0
L_wodb:
  s_mov_b32 m0, s42
  s_add_u32 s42, s42, 4096
  buffer_load_dwordx4 v20, s[68:71], s40 offen lds
  s_add_u32 s40, s40, 41472
  s_cmp_eq_u32 s40, 663552
  s_cselect_b32 s40, 0, s40
  s_cmp_lt_u32 s42, 65536
  s_cbranch_scc1 L_wodb
  s_mov_b32 m0, s42
  s_add_u32 s42, s42, 4096
  buffer_load_dwordx4 v21, s[68:71], 0 offen lds
  s_mov_b32 m0, s42
  s_mov_b32 s40, 331776
  buffer_load_dwordx4 v21, s[68:71], s40 offen lds
  s_lshl_b32 s42, s54, 10
  s_add_u32 m0, s42, 137216
  s_add_u32 s40, s49, 0
  buffer_load_dwordx4 v29, s[28:31], s40 offen lds
  s_add_u32 m0, s42, 141312
  s_add_u32 s40, s49, 36864
  buffer_load_dwordx4 v29, s[28:31], s40 offen lds
  s_add_u32 m0, s42, 145408
  s_add_u32 s40, s49, 73728
  buffer_load_dwordx4 v29, s[28:31], s40 offen lds
  s_add_u32 m0, s42, 149504
  s_add_u32 s40, s49, 110592
  buffer_load_dwordx4 v29, s[28:31], s40 offen lds
  s_mov_b32 s59, 0
  s_branch L_fl1r
L_fl0r:
  buffer_load_dword v27, v28, s[64:67], 0 offen offset:132 sc1
L_fl1r:
  s_waitcnt vmcnt(0)
  v_cmp_eq_u32 vcc, 0, v27
  s_cbranch_vccz L_fl2r
  s_add_u32 s59, s59, 1
  s_cmp_lt_u32 s59, 131072
  s_cbranch_scc1 L_fl0r
L_fl2r:
  s_mov_b32 s32, s52
  s_mov_b32 s34, s62
  s_cmp_lg_u32 s54, 3
  s_cbranch_scc1 L_hpub
  s_mov_b32 s68, s12
  s_mov_b32 s69, s13
  s_mov_b32 s70, 1152
  s_mov_b32 s71, 0x20000
  v_lshlrev_b32 v2, 2, v1
  buffer_load_dword v30, v2, s[68:71], 0 offen offset:0
  buffer_load_dword v31, v2, s[68:71], 0 offen offset:256
  buffer_load_dword v32, v2, s[68:71], 0 offen offset:512
  buffer_load_dword v33, v2, s[68:71], 0 offen offset:768
  buffer_load_dword v34, v2, s[68:71], 0 offen offset:1024
  v_mov_b32_e64 v3, 0
  s_mov_b32 s57, 0x3f803f80
  s_waitcnt vmcnt(0)
  s_nop 0
  v_add_u32 v2, 158272, v2
  ds_write_b32 v2, v30 offset:0
  ds_write_b32 v2, v31 offset:256
  ds_write_b32 v2, v32 offset:512
  ds_write_b32 v2, v33 offset:768
  ds_write_b32 v2, v34 offset:1024
  v_dot2c_f32_bf16 v3, s57, v30
  v_dot2c_f32_bf16 v3, s57, v31
  v_dot2c_f32_bf16 v3, s57, v32
  v_dot2c_f32_bf16 v3, s57, v33
  v_dot2c_f32_bf16 v3, s57, v34
  s_nop 2
  v_add_f32_dpp v3, v3, v3 quad_perm:[1,0,3,2] row_mask:0xf bank_mask:0xf
  s_nop 1
  v_add_f32_dpp v3, v3, v3 quad_perm:[2,3,0,1] row_mask:0xf bank_mask:0xf
  s_nop 1
  v_add_f32_dpp v3, v3, v3 row_half_mirror row_mask:0xf bank_mask:0xf
  s_nop 1
  v_add_f32_dpp v3, v3, v3 row_mirror row_mask:0xf bank_mask:0xf
  v_mov_b32 v4, v3
  s_nop 1
  v_permlane16_swap_b32 v3, v4
  v_add_f32 v3, v3, v4
  v_mov_b32 v4, v3
  s_nop 1
  v_permlane32_swap_b32 v3, v4
  v_add_f32_e64 v3, v3, v4
  v_mov_b32 v4, 158208
  ds_write_b32 v4, v3
  s_getreg_b32 s57, hwreg(HW_REG_XCC_ID)
  s_and_b32 s57, s57, 15
  v_mov_b32 v36, s57
  v_mov_b32_e64 v37, 0
  s_cmp_ge_u32 s53, 9
  s_cselect_b32 s57, 128, 0
  s_lshl_b32 s58, s26, 8
  s_add_u32 s57, s57, s58
  s_lshl_b32 s58, s63, 2
  s_add_u32 s57, s57, s58
  s_add_u32 s57, s57, 3065856
  s_mov_b64 exec, 1
  buffer_store_dword v36, v37, s[36:39], s57 offen sc1
  s_mov_b64 exec, -1
L_hpub:
  s_cmp_ge_u32 s53, 9
  s_cselect_b32 s57, 9, 0
  s_cselect_b32 s58, 8, 0
  s_sub_u32 s63, s53, s57
  s_lshl_b32 s60, s26, 4
  s_add_u32 s60, s60, s58
  s_add_u32 s60, s60, s3
  s_mul_i32 s61, s60, 18432
  s_add_u32 s62, s61, 393216
  s_lshl_b32 s57, s63, 7
  s_add_u32 s61, s61, s57
  s_nop 0
  s_mul_i32 s50, s3, 4608
  s_add_u32 s50, s50, 73728
  s_mul_i32 s51, s60, 2304
  s_add_u32 s51, s51, 2752512
  s_lshl_b32 s52, s63, 8
  s_add_u32 s52, s52, s51
  s_mov_b32 s44, 0x00f0000f
  s_mov_b32 s45, 0xf0000f00
  s_mov_b32 s46, 0x22222222
  s_mov_b32 s47, 0x22222222
  s_mov_b32 s48, 0xcccccccc
  s_mov_b32 s49, 0xcccccccc
  s_mov_b32 s42, 0x88888888
  s_mov_b32 s43, 0x88888888
  s_cmp_lg_u32 s54, 3
  s_cbranch_scc1 L_hpub2
  s_waitcnt lgkmcnt(0)
  s_barrier
  v_xor_b32_e64 v4, 0, v112
  ds_read_b64 v[240:241], v4
  ds_read_b64 v[132:133], v113 offset:0
  v_xor_b32_e64 v4, 32, v112
  ds_read_b64 v[242:243], v4
  ds_read_b64 v[134:135], v113 offset:32
  v_xor_b32_e64 v4, 64, v112
  ds_read_b64 v[244:245], v4
  ds_read_b64 v[136:137], v113 offset:64
  v_xor_b32 v4, 96, v112
  ds_read_b64 v[246:247], v4
  ds_read_b64 v[138:139], v113 offset:96
  v_mov_b32 v2, 158208
  ds_read_b32 v255, v2
  ds_read_b64_tr_b16 v[140:141], v236 offset:0
  ds_read_b64_tr_b16 v[142:143], v236 offset:2048
  ds_read_b64_tr_b16 v[144:145], v237 offset:0
  ds_read_b64_tr_b16 v[146:147], v237 offset:2048
  ds_read_b64_tr_b16 v[148:149], v238 offset:0
  ds_read_b64_tr_b16 v[150:151], v238 offset:2048
  ds_read_b64_tr_b16 v[152:153], v239 offset:0
  ds_read_b64_tr_b16 v[154:155], v239 offset:2048
  ds_read_b64_tr_b16 v[156:157], v236 offset:4096
  ds_read_b64_tr_b16 v[158:159], v236 offset:6144
  ds_read_b64_tr_b16 v[160:161], v237 offset:4096
  ds_read_b64_tr_b16 v[162:163], v237 offset:6144
  ds_read_b64_tr_b16 v[164:165], v238 offset:4096
  ds_read_b64_tr_b16 v[166:167], v238 offset:6144
  ds_read_b64_tr_b16 v[168:169], v239 offset:4096
  ds_read_b64_tr_b16 v[170:171], v239 offset:6144
  ds_read_b64_tr_b16 v[172:173], v236 offset:8192
  ds_read_b64_tr_b16 v[174:175], v236 offset:10240
  ds_read_b64_tr_b16 v[176:177], v237 offset:8192
  ds_read_b64_tr_b16 v[178:179], v237 offset:10240
  ds_read_b64_tr_b16 v[180:181], v238 offset:8192
  ds_read_b64_tr_b16 v[182:183], v238 offset:10240
  ds_read_b64_tr_b16 v[184:185], v239 offset:8192
  ds_read_b64_tr_b16 v[186:187], v239 offset:10240
  ds_read_b64_tr_b16 v[188:189], v236 offset:12288
  ds_read_b64_tr_b16 v[190:191], v236 offset:14336
  ds_read_b64_tr_b16 v[192:193], v237 offset:12288
  ds_read_b64_tr_b16 v[194:195], v237 offset:14336
  ds_read_b64_tr_b16 v[196:197], v238 offset:12288
  ds_read_b64_tr_b16 v[198:199], v238 offset:14336
  ds_read_b64_tr_b16 v[200:201], v239 offset:12288
  ds_read_b64_tr_b16 v[202:203], v239 offset:14336
  ds_read_b64_tr_b16 v[204:205], v236 offset:16384
  ds_read_b64_tr_b16 v[206:207], v236 offset:18432
  ds_read_b64_tr_b16 v[208:209], v237 offset:16384
  ds_read_b64_tr_b16 v[210:211], v237 offset:18432
  ds_read_b64_tr_b16 v[212:213], v238 offset:16384
  ds_read_b64_tr_b16 v[214:215], v238 offset:18432
  ds_read_b64_tr_b16 v[216:217], v239 offset:16384
  ds_read_b64_tr_b16 v[218:219], v239 offset:18432
  ds_read_b64_tr_b16 v[220:221], v236 offset:20480
  ds_read_b64_tr_b16 v[222:223], v236 offset:22528
  ds_read_b64_tr_b16 v[224:225], v237 offset:20480
  ds_read_b64_tr_b16 v[226:227], v237 offset:22528
  ds_read_b64_tr_b16 v[228:229], v238 offset:20480
  ds_read_b64_tr_b16 v[230:231], v238 offset:22528
  ds_read_b64_tr_b16 v[232:233], v239 offset:20480
  ds_read_b64_tr_b16 v[234:235], v239 offset:22528
  s_waitcnt lgkmcnt(15)
  v_lshlrev_b32 v116, 16, v240
  v_and_b32 v117, 0xffff0000, v240
  v_and_or_b32 v132, v132, v114, v115
  v_lshlrev_b32_e64 v118, 16, v241
  v_and_b32 v119, 0xffff0000, v241
  v_and_or_b32 v133, v133, v114, v115
  v_lshlrev_b32_e64 v120, 16, v242
  v_and_b32 v121, 0xffff0000, v242
  v_and_or_b32 v134, v134, v114, v115
  v_lshlrev_b32_e64 v122, 16, v243
  v_and_b32 v123, 0xffff0000, v243
  v_and_or_b32 v135, v135, v114, v115
  v_lshlrev_b32_e64 v124, 16, v244
  v_and_b32 v125, 0xffff0000, v244
  v_and_or_b32 v136, v136, v114, v115
  v_lshlrev_b32_e64 v126, 16, v245
  v_and_b32 v127, 0xffff0000, v245
  v_and_or_b32 v137, v137, v114, v115
  v_lshlrev_b32_e64 v128, 16, v246
  v_and_b32 v129, 0xffff0000, v246
  v_and_or_b32 v138, v138, v114, v115
  v_lshlrev_b32_e64 v130, 16, v247
  v_and_b32 v131, 0xffff0000, v247
  v_and_or_b32 v139, v139, v114, v115
  s_barrier
  s_mov_b32 s33, 1
  s_branch L_s3a
L_hpub2:
  s_setprio 2
  s_mov_b32 s59, 0
  s_barrier
  ds_read_b128 v[32:35], v22 offset:0
  ds_read_b128 v[36:39], v22 offset:8192
  ds_read_b128 v[40:43], v22 offset:16384
  ds_read_b128 v[44:47], v22 offset:24576
  s_waitcnt lgkmcnt(0)
  s_nop 0
  v_pk_add_f32 v[32:33], v[32:33], v[36:37]
  v_pk_add_f32 v[34:35], v[34:35], v[38:39]
  v_pk_add_f32 v[40:41], v[40:41], v[44:45]
  v_pk_add_f32 v[42:43], v[42:43], v[46:47]
  v_pk_add_f32 v[32:33], v[32:33], v[40:41]
  v_pk_add_f32 v[34:35], v[34:35], v[42:43]
  buffer_store_dwordx4 v[32:35], v25, s[36:39], s32 offen sc1
  s_setprio 0
  v_xor_b32 v4, 0, v112
  ds_read_b64 v[240:241], v4
  ds_read_b64 v[132:133], v113 offset:0
  v_xor_b32_e64 v4, 32, v112
  ds_read_b64 v[242:243], v4
  ds_read_b64 v[134:135], v113 offset:32
  v_xor_b32_e64 v4, 64, v112
  ds_read_b64 v[244:245], v4
  ds_read_b64 v[136:137], v113 offset:64
  v_xor_b32 v4, 96, v112
  ds_read_b64 v[246:247], v4
  ds_read_b64 v[138:139], v113 offset:96
  v_mov_b32 v2, 158208
  ds_read_b32 v255, v2
  ds_read_b64_tr_b16 v[140:141], v236 offset:0
  ds_read_b64_tr_b16 v[142:143], v236 offset:2048
  ds_read_b64_tr_b16 v[144:145], v237 offset:0
  ds_read_b64_tr_b16 v[146:147], v237 offset:2048
  ds_read_b64_tr_b16 v[148:149], v238 offset:0
  ds_read_b64_tr_b16 v[150:151], v238 offset:2048
  ds_read_b64_tr_b16 v[152:153], v239 offset:0
  ds_read_b64_tr_b16 v[154:155], v239 offset:2048
  ds_read_b64_tr_b16 v[156:157], v236 offset:4096
  ds_read_b64_tr_b16 v[158:159], v236 offset:6144
  ds_read_b64_tr_b16 v[160:161], v237 offset:4096
  ds_read_b64_tr_b16 v[162:163], v237 offset:6144
  ds_read_b64_tr_b16 v[164:165], v238 offset:4096
  ds_read_b64_tr_b16 v[166:167], v238 offset:6144
  ds_read_b64_tr_b16 v[168:169], v239 offset:4096
  ds_read_b64_tr_b16 v[170:171], v239 offset:6144
  ds_read_b64_tr_b16 v[172:173], v236 offset:8192
  ds_read_b64_tr_b16 v[174:175], v236 offset:10240
  ds_read_b64_tr_b16 v[176:177], v237 offset:8192
  ds_read_b64_tr_b16 v[178:179], v237 offset:10240
  ds_read_b64_tr_b16 v[180:181], v238 offset:8192
  ds_read_b64_tr_b16 v[182:183], v238 offset:10240
  ds_read_b64_tr_b16 v[184:185], v239 offset:8192
  ds_read_b64_tr_b16 v[186:187], v239 offset:10240
  ds_read_b64_tr_b16 v[188:189], v236 offset:12288
  ds_read_b64_tr_b16 v[190:191], v236 offset:14336
  ds_read_b64_tr_b16 v[192:193], v237 offset:12288
  ds_read_b64_tr_b16 v[194:195], v237 offset:14336
  ds_read_b64_tr_b16 v[196:197], v238 offset:12288
  ds_read_b64_tr_b16 v[198:199], v238 offset:14336
  ds_read_b64_tr_b16 v[200:201], v239 offset:12288
  ds_read_b64_tr_b16 v[202:203], v239 offset:14336
  ds_read_b64_tr_b16 v[204:205], v236 offset:16384
  ds_read_b64_tr_b16 v[206:207], v236 offset:18432
  ds_read_b64_tr_b16 v[208:209], v237 offset:16384
  ds_read_b64_tr_b16 v[210:211], v237 offset:18432
  ds_read_b64_tr_b16 v[212:213], v238 offset:16384
  ds_read_b64_tr_b16 v[214:215], v238 offset:18432
  ds_read_b64_tr_b16 v[216:217], v239 offset:16384
  ds_read_b64_tr_b16 v[218:219], v239 offset:18432
  ds_read_b64_tr_b16 v[220:221], v236 offset:20480
  ds_read_b64_tr_b16 v[222:223], v236 offset:22528
  ds_read_b64_tr_b16 v[224:225], v237 offset:20480
  ds_read_b64_tr_b16 v[226:227], v237 offset:22528
  ds_read_b64_tr_b16 v[228:229], v238 offset:20480
  ds_read_b64_tr_b16 v[230:231], v238 offset:22528
  ds_read_b64_tr_b16 v[232:233], v239 offset:20480
  ds_read_b64_tr_b16 v[234:235], v239 offset:22528
  s_setprio 2
  s_waitcnt vmcnt(0)
L_hA:
  s_mov_b32 s57, s34
  s_nop 0
  buffer_load_dwordx4 v[64:67], v25, s[36:39], s57 offen sc1
  s_add_u32 s57, s57, 3072
  buffer_load_dwordx4 v[68:71], v25, s[36:39], s57 offen sc1
  s_add_u32 s57, s57, 3072
  buffer_load_dwordx4 v[72:75], v25, s[36:39], s57 offen sc1
  s_add_u32 s57, s57, 3072
  buffer_load_dwordx4 v[76:79], v25, s[36:39], s57 offen sc1
  s_add_u32 s57, s57, 3072
  buffer_load_dwordx4 v[80:83], v25, s[36:39], s57 offen sc1
  s_add_u32 s57, s57, 3072
  buffer_load_dwordx4 v[84:87], v25, s[36:39], s57 offen sc1
  s_add_u32 s57, s57, 3072
  buffer_load_dwordx4 v[88:91], v25, s[36:39], s57 offen sc1
  s_add_u32 s57, s57, 3072
  buffer_load_dwordx4 v[92:95], v25, s[36:39], s57 offen sc1
  s_waitcnt vmcnt(6)
  v_pk_add_f32 v[32:33], v[64:65], v[68:69]
  v_pk_add_f32 v[34:35], v[66:67], v[70:71]
  s_waitcnt vmcnt(5)
  v_pk_add_f32 v[32:33], v[32:33], v[72:73]
  v_pk_add_f32 v[34:35], v[34:35], v[74:75]
  s_waitcnt vmcnt(4)
  v_pk_add_f32 v[32:33], v[32:33], v[76:77]
  v_pk_add_f32 v[34:35], v[34:35], v[78:79]
  s_waitcnt vmcnt(3)
  v_pk_add_f32 v[32:33], v[32:33], v[80:81]
  v_pk_add_f32 v[34:35], v[34:35], v[82:83]
  s_waitcnt vmcnt(2)
  v_pk_add_f32 v[32:33], v[32:33], v[84:85]
  v_pk_add_f32 v[34:35], v[34:35], v[86:87]
  s_waitcnt vmcnt(1)
  v_pk_add_f32 v[32:33], v[32:33], v[88:89]
  v_pk_add_f32 v[34:35], v[34:35], v[90:91]
  s_waitcnt vmcnt(0)
  s_nop 0
  v_pk_add_f32 v[32:33], v[32:33], v[92:93]
  v_pk_add_f32 v[34:35], v[34:35], v[94:95]
  v_pk_add_f32 v[36:37], v[32:33], v[34:35]
  v_cmp_u_f32 vcc, v36, v37
  s_cbranch_vccnz L_hA1
L_hA2:
  v_pk_mul_f32 v[32:33], v[32:33], v[12:13] op_sel_hi:[1,0]
  v_pk_mul_f32 v[34:35], v[34:35], v[12:13] op_sel_hi:[1,0]
  v_cvt_pk_bf16_f32 v32, v32, v33
  v_cvt_pk_bf16_f32 v33, v34, v35
  v_and_b32 v32, v32, v23
  v_and_b32 v33, v33, v24
  ds_write_b64 v26, v[32:33]
  s_waitcnt lgkmcnt(0)
  s_barrier
  s_setprio 0
  s_branch L_s3un
L_hA1:
  v_max3_u32 v2, v64, v65, v66
  v_max3_u32 v2, v2, v67, v68
  v_max3_u32 v2, v2, v69, v70
  v_max3_u32 v2, v2, v71, v72
  v_max3_u32 v2, v2, v73, v74
  v_max3_u32 v2, v2, v75, v76
  v_max3_u32 v2, v2, v77, v78
  v_max3_u32 v2, v2, v79, v80
  v_max3_u32 v2, v2, v81, v82
  v_max3_u32 v2, v2, v83, v84
  v_max3_u32 v2, v2, v85, v86
  v_max3_u32 v2, v2, v87, v88
  v_max3_u32 v2, v2, v89, v90
  v_max3_u32 v2, v2, v91, v92
  v_max3_u32 v2, v2, v93, v94
  v_max_u32 v2, v2, v95
  v_cmp_eq_u32 vcc, -1, v2
  s_cbranch_vccz L_hA2
  s_add_u32 s59, s59, 1
  s_cmp_lt_u32 s59, 131072
  s_cbranch_scc1 L_hA
  s_branch L_hA2
L_compute:
  v_lshrrev_b32 v15, 1, v13
  v_xor_b32 v15, v15, v14
  v_lshlrev_b32_e64 v15, 4, v15
  v_lshl_add_u32 v4, v13, 7, v15
  s_lshl_b32 s55, s54, 13
  v_add_u32 v4, s55, v4
  v_xor_b32 v5, 64, v4
  v_lshrrev_b32 v2, 2, v13
  v_lshl_add_u32 v2, v14, 2, v2
  v_and_b32 v3, 3, v13
  v_and_b32 v15, 7, v2
  v_lshlrev_b32 v15, 5, v15
  v_lshlrev_b32 v2, 8, v2
  v_add_u32 v2, 32768, v2
  v_add_u32 v16, 3, v3
  v_and_b32 v16, 4, v16
  v_lshlrev_b32 v16, 1, v16
  v_and_b32 v17, 2, v3
  v_lshlrev_b32 v17, 2, v17
  v_lshlrev_b32 v3, 3, v3
  v_add_u32 v3, s52, v3
  s_lshl_b32 s56, s47, 1
  s_sub_u32 s57, 2, s56
  s_lshl_b32 s58, s47, 4
  s_sub_u32 s58, 8, s58
  v_mul_u32_u24 v16, s57, v16
  v_mul_u32_u24 v17, s56, v17
  v_add_u32 v17, s58, v17
  v_add_u32 v6, 0, v3
  v_xor_b32 v6, v6, v15
  v_add_u32 v6, v6, v2
  v_add_u32 v7, 32, v3
  v_xor_b32 v7, v7, v15
  v_add_u32 v7, v7, v2
  v_add_u32 v8, 64, v3
  v_add_u32 v8, v8, v16
  v_xor_b32 v8, v8, v15
  v_add_u32 v8, v8, v2
  v_add_u32 v9, 104, v3
  v_add_u32 v9, s58, v9
  v_xor_b32 v9, v9, v15
  v_add_u32_e64 v9, v9, v2
  v_add_u32 v10, 136, v3
  v_add_u32 v10, v10, v17
  v_xor_b32 v10, v10, v15
  v_add_u32_e64 v10, v10, v2
  v_add_u32 v11, 176, v3
  v_xor_b32 v11, v11, v15
  v_add_u32 v11, v11, v2
  v_add_u32 v12, 208, v3
  v_xor_b32 v12, v12, v15
  v_add_u32_e64 v12, v12, v2
  s_lshl_b32 s55, s54, 8
  s_add_u32 s55, s55, 153600
  v_lshl_add_u32 v249, v14, 4, s55
  v_lshlrev_b32_e64 v250, 2, v13
  v_add_u32 v250, 155648, v250
  v_cmp_le_u32 s[40:41], 12, v13
  s_nop 1
  s_nop 0
  v_cndmask_b32_e64 v251, 0, -1, s[40:41]
  s_mul_i32 s55, s54, 7680
  s_add_u32 s55, s55, 106496
  v_mul_u32_u24_e64 v252, 40, v13
  v_lshl_add_u32 v252, v14, 3, v252
  v_add_u32 v252, s55, v252
  v_lshrrev_b32 v254, 2, v13
  v_add_u32_e64 v254, v254, v13
  v_lshl_add_u32 v254, v254, 3, s55
  v_mul_u32_u24 v253, 160, v14
  v_add_u32 v253, v253, v254
  s_lshl_b32 s55, s54, 13
  s_add_u32 s55, s55, 73728
  v_lshl_add_u32 v255, v1, 4, s55
  v_mov_b32 v172, 0
  v_mov_b32 v173, 0
  v_mov_b32 v174, 0
  v_mov_b32_e64 v175, 0
  s_nop 1
  v_mfma_f32_16x16x32_bf16 v[16:19], v[172:175], v[172:175], 0
  v_mfma_f32_16x16x32_bf16 v[20:23], v[172:175], v[172:175], 0
  v_mfma_f32_16x16x32_bf16 v[24:27], v[172:175], v[172:175], 0
  v_mfma_f32_16x16x32_bf16 v[28:31], v[172:175], v[172:175], 0
  v_mfma_f32_16x16x32_bf16 v[32:35], v[172:175], v[172:175], 0
  v_mfma_f32_16x16x32_bf16 v[36:39], v[172:175], v[172:175], 0
  v_mfma_f32_16x16x32_bf16 v[40:43], v[172:175], v[172:175], 0
  v_mfma_f32_16x16x32_bf16 v[44:47], v[172:175], v[172:175], 0
  v_mfma_f32_16x16x32_bf16 v[48:51], v[172:175], v[172:175], 0
  v_mfma_f32_16x16x32_bf16 v[52:55], v[172:175], v[172:175], 0
  v_mfma_f32_16x16x32_bf16 v[56:59], v[172:175], v[172:175], 0
  v_mfma_f32_16x16x32_bf16 v[60:63], v[172:175], v[172:175], 0
  v_mfma_f32_16x16x32_bf16 v[64:67], v[172:175], v[172:175], 0
  v_mfma_f32_16x16x32_bf16 v[68:71], v[172:175], v[172:175], 0
  v_mfma_f32_16x16x32_bf16 v[72:75], v[172:175], v[172:175], 0
  v_mfma_f32_16x16x32_bf16 v[76:79], v[172:175], v[172:175], 0
  v_mfma_f32_16x16x32_bf16 v[80:83], v[172:175], v[172:175], 0
  v_mfma_f32_16x16x32_bf16 v[84:87], v[172:175], v[172:175], 0
  v_mfma_f32_16x16x32_bf16 v[88:91], v[172:175], v[172:175], 0
  v_mfma_f32_16x16x32_bf16 v[92:95], v[172:175], v[172:175], 0
  v_mfma_f32_16x16x32_bf16 v[96:99], v[172:175], v[172:175], 0
  v_mfma_f32_16x16x32_bf16 v[100:103], v[172:175], v[172:175], 0
  v_mfma_f32_16x16x32_bf16 v[104:107], v[172:175], v[172:175], 0
  v_mfma_f32_16x16x32_bf16 v[108:111], v[172:175], v[172:175], 0
  v_mfma_f32_16x16x32_bf16 v[112:115], v[172:175], v[172:175], 0
  v_mfma_f32_16x16x32_bf16 v[116:119], v[172:175], v[172:175], 0
  v_mfma_f32_16x16x32_bf16 v[120:123], v[172:175], v[172:175], 0
  v_mfma_f32_16x16x32_bf16 v[124:127], v[172:175], v[172:175], 0
  s_mov_b32 s55, 0
  s_mov_b32 s56, 0
  s_mov_b32 s58, 49152
  s_waitcnt lgkmcnt(0)
  s_mov_b32 s36, s24
  s_mov_b32 s37, s25
  s_mov_b32 s38, 268435456
  s_mov_b32 s39, 0x20000
  s_mov_b32 s28, s4
  s_mov_b32 s29, s5
  s_mov_b32 s30, 2359296
  s_mov_b32 s31, 0x20000
  s_movk_i32 s57, 190
  v_lshl_add_u32 v212, s54, 6, v1
  v_cmp_gt_u32 s[40:41], s57, v212
  s_nop 1
  v_cndmask_b32_e64 v213, 0, v212, s[40:41]
  v_cndmask_b32_e64 v233, 0, -1, s[40:41]
  v_mov_b32 v234, v233
  v_mul_u32_u24 v214, 13108, v213
  v_lshrrev_b32 v214, 16, v214
  v_mul_u32_u24 v215, 5, v214
  v_sub_u32_e64 v215, v213, v215
  v_cmp_le_u32 s[40:41], 18, v214
  s_nop 1
  v_cndmask_b32_e64 v216, 0, 1, s[40:41]
  v_cmp_le_u32 s[40:41], 36, v214
  v_subrev_u32_e64 v217, 36, v214
  s_nop 0
  v_cndmask_b32_e64 v216, v216, v217, s[40:41]
  v_cndmask_b32_e64 v214, v214, 36, s[40:41]
  v_mov_b32 v222, 0x3ef5fdf0
  v_mov_b32 v221, 0x3f317218
  v_cndmask_b32_e64 v222, v222, v221, s[40:41]
  v_lshl_add_u32 v217, v216, 2, v215
  v_add_u32 v214, 72, v214
  v_lshrrev_b32 v218, 4, v214
  v_subrev_u32 v218, 4, v218
  v_and_b32 v214, 15, v214
  v_lshrrev_b32 v219, 2, v217
  v_mad_u32_u24 v218, v219, 3, v218
  v_lshrrev_b32 v220, 1, v219
  v_sub_u32 v218, v218, v220
  v_and_b32_e64 v219, 3, v217
  v_lshl_add_u32 v214, v219, 4, v214
  v_lshlrev_b32_e64 v214, 4, v214
  v_lshl_add_u32 v232, v218, 10, v214
  v_add_u32 v232, 73728, v232
  v_cmp_eq_u32 s[40:41], 4, v217
  s_nop 1
  v_cndmask_b32_e64 v218, -1, 0, s[40:41]
  v_subrev_u32 v219, 1, v216
  v_or_b32 v219, v219, v218
  v_and_b32 v233, v233, v219
  v_sub_u32 v219, 0, v216
  v_or_b32 v219, v219, v218
  v_and_b32 v234, v234, v219
  v_lshlrev_b32 v212, 2, v212
  v_add_u32 v212, 147456, v212
  ds_write_b32 v212, v232
  ds_write_b32 v212, v233 offset:1024
  ds_write_b32 v212, v234 offset:2048
  ds_write_b32 v212, v222 offset:3072
  v_lshrrev_b32_e64 v212, 3, v13
  v_bfe_u32 v213, v13, 2, 1
  v_and_b32 v214, 3, v13
  v_mul_u32_u24 v215, 18, v212
  v_mad_u32_u24 v215, v213, 10, v215
  v_add_u32_e64 v215, v215, v214
  v_lshl_add_u32 v215, s54, 2, v215
  s_mov_b64 s[70:71], -1
  s_cmp_lg_u32 s54, 2
  s_cbranch_scc1 L_kta
  v_add_u32 v216, 36, v212
  v_cmp_eq_u32 s[68:69], 2, v214
  s_nop 1
  s_nop 0
  v_cndmask_b32_e64 v215, v215, v216, s[68:69]
  v_lshl_add_u32 v216, v213, 2, v214
  v_cmp_gt_u32 s[70:71], 2, v216
  s_nop 0
  s_or_b64 s[70:71], s[70:71], s[68:69]
L_kta:
  v_lshlrev_b32 v216, 2, v212
  v_sub_u32 v216, v14, v216
  v_mov_b32 v217, 190
  s_mul_i32 s57, s54, 768
  s_add_u32 s57, s57, 159616
  v_lshl_add_u32 v218, v1, 2, s57
  s_mov_b32 s57, 156672
  v_add_u32_e64 v219, 0, v216
  v_cmp_gt_u32 s[68:69], 5, v219
  v_mad_u32_u24 v219, v215, 5, v219
  s_and_b64 s[68:69], s[68:69], s[70:71]
  s_nop 0
  v_cndmask_b32_e64 v219, v217, v219, s[68:69]
  v_lshl_add_u32 v219, v219, 3, s57
  ds_write_b32 v218, v219 offset:0
  v_add_u32_e64 v219, 4, v216
  v_cmp_gt_u32 s[68:69], 5, v219
  v_mad_u32_u24 v219, v215, 5, v219
  s_and_b64 s[68:69], s[68:69], s[70:71]
  s_nop 0
  v_cndmask_b32_e64 v219, v217, v219, s[68:69]
  v_lshl_add_u32 v219, v219, 3, s57
  ds_write_b32 v218, v219 offset:256
  v_add_u32_e64 v219, 8, v216
  v_cmp_gt_u32 s[68:69], 5, v219
  v_mad_u32_u24 v219, v215, 5, v219
  s_and_b64 s[68:69], s[68:69], s[70:71]
  s_nop 0
  v_cndmask_b32_e64 v219, v217, v219, s[68:69]
  v_lshl_add_u32 v219, v219, 3, s57
  ds_write_b32 v218, v219 offset:512
  s_waitcnt lgkmcnt(0)
  s_barrier
  ds_read_b128 v[128:131], v4 offset:0
  ds_read_b128 v[132:135], v4 offset:2048
  ds_read_b128 v[136:139], v4 offset:4096
  ds_read_b128 v[140:143], v4 offset:6144
  ds_read_b64_tr_b16 v[144:145], v6 offset:0
  ds_read_b64_tr_b16 v[146:147], v6 offset:4096
  ds_read_b64_tr_b16 v[148:149], v7 offset:0
  ds_read_b64_tr_b16 v[150:151], v7 offset:4096
  ds_read_b64_tr_b16 v[152:153], v8 offset:0
  ds_read_b64_tr_b16 v[154:155], v8 offset:4096
  ds_read_b64_tr_b16 v[156:157], v9 offset:0
  ds_read_b64_tr_b16 v[158:159], v9 offset:4096
  ds_read_b64_tr_b16 v[160:161], v10 offset:0
  ds_read_b64_tr_b16 v[162:163], v10 offset:4096
  ds_read_b64_tr_b16 v[164:165], v11 offset:0
  ds_read_b64_tr_b16 v[166:167], v11 offset:4096
  ds_read_b64_tr_b16 v[168:169], v12 offset:0
  ds_read_b64_tr_b16 v[170:171], v12 offset:4096
  s_waitcnt lgkmcnt(0)
  s_branch L_cloop
  .p2align 3
L_cloop2:
  v_mfma_f32_16x16x32_bf16 v[80:83], v[180:183], v[196:199], v[80:83]
  ds_read_b128 v[128:131], v4 offset:0
  v_mfma_f32_16x16x32_bf16 v[108:111], v[184:187], v[196:199], v[108:111]
  ds_read_b128 v[132:135], v4 offset:2048
  v_mfma_f32_16x16x32_bf16 v[28:31], v[172:175], v[200:203], v[28:31]
  ds_read_b128 v[136:139], v4 offset:4096
  v_mfma_f32_16x16x32_bf16 v[56:59], v[176:179], v[200:203], v[56:59]
  ds_read_b128 v[140:143], v4 offset:6144
  v_mfma_f32_16x16x32_bf16 v[84:87], v[180:183], v[200:203], v[84:87]
  ds_read_b64_tr_b16 v[144:145], v6 offset:0
  v_mfma_f32_16x16x32_bf16 v[112:115], v[184:187], v[200:203], v[112:115]
  ds_read_b64_tr_b16 v[146:147], v6 offset:4096
  v_mfma_f32_16x16x32_bf16 v[32:35], v[172:175], v[204:207], v[32:35]
  ds_read_b64_tr_b16 v[148:149], v7 offset:0
  v_mfma_f32_16x16x32_bf16 v[60:63], v[176:179], v[204:207], v[60:63]
  ds_read_b64_tr_b16 v[150:151], v7 offset:4096
  v_mfma_f32_16x16x32_bf16 v[88:91], v[180:183], v[204:207], v[88:91]
  ds_read_b64_tr_b16 v[152:153], v8 offset:0
  v_mfma_f32_16x16x32_bf16 v[116:119], v[184:187], v[204:207], v[116:119]
  ds_read_b64_tr_b16 v[154:155], v8 offset:4096
  v_mfma_f32_16x16x32_bf16 v[36:39], v[172:175], v[208:211], v[36:39]
  ds_read_b64_tr_b16 v[156:157], v9 offset:0
  v_mfma_f32_16x16x32_bf16 v[64:67], v[176:179], v[208:211], v[64:67]
  ds_read_b64_tr_b16 v[158:159], v9 offset:4096
  v_mfma_f32_16x16x32_bf16 v[92:95], v[180:183], v[208:211], v[92:95]
  ds_read_b64_tr_b16 v[160:161], v10 offset:0
  v_mfma_f32_16x16x32_bf16 v[120:123], v[184:187], v[208:211], v[120:123]
  ds_read_b64_tr_b16 v[162:163], v10 offset:4096
  v_mfma_f32_16x16x32_bf16 v[40:43], v[172:175], v[212:215], v[40:43]
  ds_read_b64_tr_b16 v[164:165], v11 offset:0
  v_mfma_f32_16x16x32_bf16 v[68:71], v[176:179], v[212:215], v[68:71]
  ds_read_b64_tr_b16 v[166:167], v11 offset:4096
  v_mfma_f32_16x16x32_bf16 v[96:99], v[180:183], v[212:215], v[96:99]
  ds_read_b64_tr_b16 v[168:169], v12 offset:0
  v_mfma_f32_16x16x32_bf16 v[124:127], v[184:187], v[212:215], v[124:127]
  ds_read_b64_tr_b16 v[170:171], v12 offset:4096
  s_waitcnt lgkmcnt(6)
L_cloop:
  v_mfma_f32_16x16x32_bf16 v[16:19], v[128:131], v[144:147], v[16:19]
  ds_read_b128 v[172:175], v5 offset:0
  s_add_u32 s56, s56, 1
  s_cmp_eq_u32 s56, 3
  s_nop 0
  v_mfma_f32_16x16x32_bf16 v[44:47], v[132:135], v[144:147], v[44:47]
  ds_read_b128 v[176:179], v5 offset:2048
  s_cselect_b32 s57, 4294868992, s58
  s_cselect_b32 s56, 0, s56
  v_mfma_f32_16x16x32_bf16 v[72:75], v[136:139], v[144:147], v[72:75]
  ds_read_b128 v[180:183], v5 offset:4096
  v_add_u32 v4, s57, v4
  v_mfma_f32_16x16x32_bf16 v[100:103], v[140:143], v[144:147], v[100:103]
  ds_read_b128 v[184:187], v5 offset:6144
  v_mfma_f32_16x16x32_bf16 v[20:23], v[128:131], v[148:151], v[20:23]
  ds_read_b64_tr_b16 v[188:189], v6 offset:8192
  v_add_u32_e64 v5, s57, v5
  v_mfma_f32_16x16x32_bf16 v[48:51], v[132:135], v[148:151], v[48:51]
  ds_read_b64_tr_b16 v[190:191], v6 offset:12288
  v_mfma_f32_16x16x32_bf16 v[76:79], v[136:139], v[148:151], v[76:79]
  ds_read_b64_tr_b16 v[192:193], v7 offset:8192
  v_add_u32_e64 v6, s57, v6
  v_mfma_f32_16x16x32_bf16 v[104:107], v[140:143], v[148:151], v[104:107]
  ds_read_b64_tr_b16 v[194:195], v7 offset:12288
  v_mfma_f32_16x16x32_bf16 v[24:27], v[128:131], v[152:155], v[24:27]
  ds_read_b64_tr_b16 v[196:197], v8 offset:8192
  v_add_u32_e64 v7, s57, v7
  v_mfma_f32_16x16x32_bf16 v[52:55], v[132:135], v[152:155], v[52:55]
  ds_read_b64_tr_b16 v[198:199], v8 offset:12288
  s_waitcnt lgkmcnt(10)
  v_mfma_f32_16x16x32_bf16 v[80:83], v[136:139], v[152:155], v[80:83]
  ds_read_b64_tr_b16 v[200:201], v9 offset:8192
  v_add_u32 v8, s57, v8
  v_mfma_f32_16x16x32_bf16 v[108:111], v[140:143], v[152:155], v[108:111]
  ds_read_b64_tr_b16 v[202:203], v9 offset:12288
  v_mfma_f32_16x16x32_bf16 v[28:31], v[128:131], v[156:159], v[28:31]
  ds_read_b64_tr_b16 v[204:205], v10 offset:8192
  v_add_u32_e64 v9, s57, v9
  v_mfma_f32_16x16x32_bf16 v[56:59], v[132:135], v[156:159], v[56:59]
  ds_read_b64_tr_b16 v[206:207], v10 offset:12288
  v_mfma_f32_16x16x32_bf16 v[84:87], v[136:139], v[156:159], v[84:87]
  ds_read_b64_tr_b16 v[208:209], v11 offset:8192
  v_add_u32_e64 v10, s57, v10
  v_mfma_f32_16x16x32_bf16 v[112:115], v[140:143], v[156:159], v[112:115]
  ds_read_b64_tr_b16 v[210:211], v11 offset:12288
  v_mfma_f32_16x16x32_bf16 v[32:35], v[128:131], v[160:163], v[32:35]
  ds_read_b64_tr_b16 v[212:213], v12 offset:8192
  v_add_u32_e64 v11, s57, v11
  v_mfma_f32_16x16x32_bf16 v[60:63], v[132:135], v[160:163], v[60:63]
  ds_read_b64_tr_b16 v[214:215], v12 offset:12288
  v_mfma_f32_16x16x32_bf16 v[88:91], v[136:139], v[160:163], v[88:91]
  v_add_u32_e64 v12, s57, v12
  v_mfma_f32_16x16x32_bf16 v[116:119], v[140:143], v[160:163], v[116:119]
  v_mfma_f32_16x16x32_bf16 v[36:39], v[128:131], v[164:167], v[36:39]
  v_mfma_f32_16x16x32_bf16 v[64:67], v[132:135], v[164:167], v[64:67]
  v_mfma_f32_16x16x32_bf16 v[92:95], v[136:139], v[164:167], v[92:95]
  s_add_u32 s55, s55, 1
  s_cmp_lt_u32 s55, 9
  v_mfma_f32_16x16x32_bf16 v[120:123], v[140:143], v[164:167], v[120:123]
  v_mfma_f32_16x16x32_bf16 v[40:43], v[128:131], v[168:171], v[40:43]
  v_mfma_f32_16x16x32_bf16 v[68:71], v[132:135], v[168:171], v[68:71]
  v_mfma_f32_16x16x32_bf16 v[96:99], v[136:139], v[168:171], v[96:99]
  v_mfma_f32_16x16x32_bf16 v[124:127], v[140:143], v[168:171], v[124:127]
  s_waitcnt lgkmcnt(0)
  s_nop 0
  v_mfma_f32_16x16x32_bf16 v[16:19], v[172:175], v[188:191], v[16:19]
  v_mfma_f32_16x16x32_bf16 v[44:47], v[176:179], v[188:191], v[44:47]
  v_mfma_f32_16x16x32_bf16 v[72:75], v[180:183], v[188:191], v[72:75]
  v_mfma_f32_16x16x32_bf16 v[100:103], v[184:187], v[188:191], v[100:103]
  v_mfma_f32_16x16x32_bf16 v[20:23], v[172:175], v[192:195], v[20:23]
  v_mfma_f32_16x16x32_bf16 v[48:51], v[176:179], v[192:195], v[48:51]
  v_mfma_f32_16x16x32_bf16 v[76:79], v[180:183], v[192:195], v[76:79]
  v_mfma_f32_16x16x32_bf16 v[104:107], v[184:187], v[192:195], v[104:107]
  v_mfma_f32_16x16x32_bf16 v[24:27], v[172:175], v[196:199], v[24:27]
  v_mfma_f32_16x16x32_bf16 v[52:55], v[176:179], v[196:199], v[52:55]
  s_barrier
  s_cbranch_scc1 L_cloop2
  v_mfma_f32_16x16x32_bf16 v[80:83], v[180:183], v[196:199], v[80:83]
  ds_read_b32 v160, v250 offset:0
  v_mfma_f32_16x16x32_bf16 v[108:111], v[184:187], v[196:199], v[108:111]
  ds_read_b32 v162, v250 offset:64
  v_mfma_f32_16x16x32_bf16 v[28:31], v[172:175], v[200:203], v[28:31]
  ds_read_b32 v164, v250 offset:128
  v_mfma_f32_16x16x32_bf16 v[56:59], v[176:179], v[200:203], v[56:59]
  ds_read_b32 v166, v250 offset:192
  v_mfma_f32_16x16x32_bf16 v[84:87], v[180:183], v[200:203], v[84:87]
  ds_read_b32 v168, v250 offset:256
  v_mfma_f32_16x16x32_bf16 v[112:115], v[184:187], v[200:203], v[112:115]
  ds_read_b32 v170, v250 offset:320
  v_mfma_f32_16x16x32_bf16 v[32:35], v[172:175], v[204:207], v[32:35]
  ds_read_b32 v10, v250 offset:384
  v_mfma_f32_16x16x32_bf16 v[60:63], v[176:179], v[204:207], v[60:63]
  ds_read_b128 v[128:131], v249 offset:0
  v_mfma_f32_16x16x32_bf16 v[88:91], v[180:183], v[204:207], v[88:91]
  ds_read_b128 v[144:147], v249 offset:1024
  v_mfma_f32_16x16x32_bf16 v[116:119], v[184:187], v[204:207], v[116:119]
  ds_read_b128 v[132:135], v249 offset:64
  v_mfma_f32_16x16x32_bf16 v[36:39], v[172:175], v[208:211], v[36:39]
  ds_read_b128 v[148:151], v249 offset:1088
  v_mfma_f32_16x16x32_bf16 v[64:67], v[176:179], v[208:211], v[64:67]
  ds_read_b128 v[136:139], v249 offset:128
  v_mfma_f32_16x16x32_bf16 v[92:95], v[180:183], v[208:211], v[92:95]
  ds_read_b128 v[152:155], v249 offset:1152
  v_mfma_f32_16x16x32_bf16 v[120:123], v[184:187], v[208:211], v[120:123]
  ds_read_b128 v[140:143], v249 offset:192
  v_mfma_f32_16x16x32_bf16 v[40:43], v[172:175], v[212:215], v[40:43]
  ds_read_b128 v[156:159], v249 offset:1216
  v_mfma_f32_16x16x32_bf16 v[68:71], v[176:179], v[212:215], v[68:71]
  v_mov_b32 v4, 0x3fb8aa47
  v_mfma_f32_16x16x32_bf16 v[96:99], v[180:183], v[212:215], v[96:99]
  v_mov_b32 v6, 0x3f07de67
  v_mfma_f32_16x16x32_bf16 v[124:127], v[184:187], v[212:215], v[124:127]
  v_mov_b32 v8, 0x35c1a2a0
  v_mov_b32 v2, 0x3f803f80
  s_waitcnt lgkmcnt(0)
  s_nop 0
  v_pk_mul_f32 v[212:213], v[144:145], v[168:169] op_sel_hi:[1,0]
  v_pk_mul_f32 v[214:215], v[146:147], v[168:169] op_sel_hi:[1,0]
  v_pk_fma_f32 v[212:213], v[32:33], v[128:129], v[212:213]
  v_pk_fma_f32 v[214:215], v[34:35], v[130:131], v[214:215]
  v_cvt_pk_bf16_f32 v216, v212, v213
  v_cvt_pk_bf16_f32 v217, v214, v215
  v_pk_mul_f32 v[212:213], v[148:149], v[168:169] op_sel_hi:[1,0]
  v_pk_mul_f32 v[214:215], v[150:151], v[168:169] op_sel_hi:[1,0]
  v_pk_fma_f32 v[212:213], v[60:61], v[132:133], v[212:213]
  v_pk_fma_f32 v[214:215], v[62:63], v[134:135], v[214:215]
  v_cvt_pk_bf16_f32 v218, v212, v213
  v_cvt_pk_bf16_f32 v219, v214, v215
  v_pk_mul_f32 v[212:213], v[152:153], v[168:169] op_sel_hi:[1,0]
  v_pk_mul_f32 v[214:215], v[154:155], v[168:169] op_sel_hi:[1,0]
  v_pk_fma_f32 v[212:213], v[88:89], v[136:137], v[212:213]
  v_pk_fma_f32 v[214:215], v[90:91], v[138:139], v[214:215]
  v_cvt_pk_bf16_f32 v220, v212, v213
  v_cvt_pk_bf16_f32 v221, v214, v215
  v_pk_mul_f32 v[212:213], v[156:157], v[168:169] op_sel_hi:[1,0]
  v_pk_mul_f32 v[214:215], v[158:159], v[168:169] op_sel_hi:[1,0]
  v_pk_fma_f32 v[212:213], v[116:117], v[140:141], v[212:213]
  v_pk_fma_f32 v[214:215], v[118:119], v[142:143], v[214:215]
  v_cvt_pk_bf16_f32 v222, v212, v213
  v_cvt_pk_bf16_f32 v223, v214, v215
  v_pk_mul_f32 v[212:213], v[144:145], v[170:171] op_sel_hi:[1,0]
  v_pk_mul_f32 v[214:215], v[146:147], v[170:171] op_sel_hi:[1,0]
  v_pk_fma_f32 v[212:213], v[36:37], v[128:129], v[212:213]
  v_pk_fma_f32 v[214:215], v[38:39], v[130:131], v[214:215]
  v_cvt_pk_bf16_f32 v224, v212, v213
  v_cvt_pk_bf16_f32 v225, v214, v215
  v_pk_mul_f32 v[212:213], v[148:149], v[170:171] op_sel_hi:[1,0]
  v_pk_mul_f32 v[214:215], v[150:151], v[170:171] op_sel_hi:[1,0]
  v_pk_fma_f32 v[212:213], v[64:65], v[132:133], v[212:213]
  v_pk_fma_f32 v[214:215], v[66:67], v[134:135], v[214:215]
  v_cvt_pk_bf16_f32 v226, v212, v213
  v_cvt_pk_bf16_f32 v227, v214, v215
  v_pk_mul_f32 v[212:213], v[152:153], v[170:171] op_sel_hi:[1,0]
  v_pk_mul_f32 v[214:215], v[154:155], v[170:171] op_sel_hi:[1,0]
  v_pk_fma_f32 v[212:213], v[92:93], v[136:137], v[212:213]
  v_pk_fma_f32 v[214:215], v[94:95], v[138:139], v[214:215]
  v_cvt_pk_bf16_f32 v228, v212, v213
  v_cvt_pk_bf16_f32 v229, v214, v215
  v_pk_mul_f32 v[212:213], v[156:157], v[170:171] op_sel_hi:[1,0]
  v_pk_mul_f32 v[214:215], v[158:159], v[170:171] op_sel_hi:[1,0]
  v_pk_fma_f32 v[212:213], v[120:121], v[140:141], v[212:213]
  v_pk_fma_f32 v[214:215], v[122:123], v[142:143], v[214:215]
  v_cvt_pk_bf16_f32 v230, v212, v213
  v_cvt_pk_bf16_f32 v231, v214, v215
  v_pk_mul_f32 v[212:213], v[144:145], v[10:11] op_sel_hi:[1,0]
  v_pk_mul_f32 v[214:215], v[146:147], v[10:11] op_sel_hi:[1,0]
  v_pk_fma_f32 v[212:213], v[40:41], v[128:129], v[212:213]
  v_pk_fma_f32 v[214:215], v[42:43], v[130:131], v[214:215]
  v_cvt_pk_bf16_f32 v232, v212, v213
  v_cvt_pk_bf16_f32 v233, v214, v215
  v_pk_mul_f32 v[212:213], v[148:149], v[10:11] op_sel_hi:[1,0]
  v_pk_mul_f32 v[214:215], v[150:151], v[10:11] op_sel_hi:[1,0]
  v_pk_fma_f32 v[212:213], v[68:69], v[132:133], v[212:213]
  v_pk_fma_f32 v[214:215], v[70:71], v[134:135], v[214:215]
  v_cvt_pk_bf16_f32 v234, v212, v213
  v_cvt_pk_bf16_f32 v235, v214, v215
  v_pk_mul_f32 v[212:213], v[152:153], v[10:11] op_sel_hi:[1,0]
  v_pk_mul_f32 v[214:215], v[154:155], v[10:11] op_sel_hi:[1,0]
  v_pk_fma_f32 v[212:213], v[96:97], v[136:137], v[212:213]
  v_pk_fma_f32 v[214:215], v[98:99], v[138:139], v[214:215]
  v_cvt_pk_bf16_f32 v236, v212, v213
  v_cvt_pk_bf16_f32 v237, v214, v215
  v_pk_mul_f32 v[212:213], v[156:157], v[10:11] op_sel_hi:[1,0]
  v_pk_mul_f32 v[214:215], v[158:159], v[10:11] op_sel_hi:[1,0]
  v_pk_fma_f32 v[212:213], v[124:125], v[140:141], v[212:213]
  v_pk_fma_f32 v[214:215], v[126:127], v[142:143], v[214:215]
  v_cvt_pk_bf16_f32 v238, v212, v213
  v_cvt_pk_bf16_f32 v239, v214, v215
  v_bfi_b32 v232, v251, v2, v232
  v_bfi_b32 v233, v251, v2, v233
  v_bfi_b32 v234, v251, v2, v234
  v_bfi_b32 v235, v251, v2, v235
  v_bfi_b32 v236, v251, v2, v236
  v_bfi_b32 v237, v251, v2, v237
  v_bfi_b32 v238, v251, v2, v238
  v_bfi_b32 v239, v251, v2, v239
  v_pk_fma_f32 v[204:205], v[144:145], v[160:161], v[4:5] op_sel_hi:[1,0,0]
  v_pk_fma_f32 v[206:207], v[146:147], v[160:161], v[4:5] op_sel_hi:[1,0,0]
  v_pk_fma_f32 v[204:205], v[16:17], v[128:129], v[204:205]
  v_pk_fma_f32 v[206:207], v[18:19], v[130:131], v[206:207]
  v_exp_f32 v208, v204
  v_exp_f32 v209, v205
  v_exp_f32 v210, v206
  v_exp_f32 v211, v207
  v_pk_fma_f32 v[208:209], v[208:209], v[6:7], v[8:9] op_sel_hi:[1,0,0]
  v_pk_fma_f32 v[210:211], v[210:211], v[6:7], v[8:9] op_sel_hi:[1,0,0]
  v_med3_f32 v208, v204, v208, v4
  v_med3_f32 v209, v205, v209, v4
  v_med3_f32 v210, v206, v210, v4
  v_med3_f32 v211, v207, v211, v4
  v_cvt_pk_bf16_f32 v36, v208, v209
  v_cvt_pk_bf16_f32 v37, v210, v211
  v_pk_fma_f32 v[204:205], v[148:149], v[160:161], v[4:5] op_sel_hi:[1,0,0]
  v_pk_fma_f32 v[206:207], v[150:151], v[160:161], v[4:5] op_sel_hi:[1,0,0]
  v_pk_fma_f32 v[204:205], v[44:45], v[132:133], v[204:205]
  v_pk_fma_f32 v[206:207], v[46:47], v[134:135], v[206:207]
  v_exp_f32 v208, v204
  v_exp_f32 v209, v205
  v_exp_f32 v210, v206
  v_exp_f32 v211, v207
  v_pk_fma_f32 v[208:209], v[208:209], v[6:7], v[8:9] op_sel_hi:[1,0,0]
  v_pk_fma_f32 v[210:211], v[210:211], v[6:7], v[8:9] op_sel_hi:[1,0,0]
  v_med3_f32 v208, v204, v208, v4
  v_med3_f32 v209, v205, v209, v4
  v_med3_f32 v210, v206, v210, v4
  v_med3_f32 v211, v207, v211, v4
  v_cvt_pk_bf16_f32 v38, v208, v209
  v_cvt_pk_bf16_f32 v39, v210, v211
  v_pk_fma_f32 v[204:205], v[152:153], v[160:161], v[4:5] op_sel_hi:[1,0,0]
  v_pk_fma_f32 v[206:207], v[154:155], v[160:161], v[4:5] op_sel_hi:[1,0,0]
  v_pk_fma_f32 v[204:205], v[72:73], v[136:137], v[204:205]
  v_pk_fma_f32 v[206:207], v[74:75], v[138:139], v[206:207]
  v_exp_f32 v208, v204
  v_exp_f32 v209, v205
  v_exp_f32 v210, v206
  v_exp_f32 v211, v207
  v_pk_fma_f32 v[208:209], v[208:209], v[6:7], v[8:9] op_sel_hi:[1,0,0]
  v_pk_fma_f32 v[210:211], v[210:211], v[6:7], v[8:9] op_sel_hi:[1,0,0]
  v_med3_f32 v208, v204, v208, v4
  v_med3_f32 v209, v205, v209, v4
  v_med3_f32 v210, v206, v210, v4
  v_med3_f32 v211, v207, v211, v4
  v_cvt_pk_bf16_f32 v40, v208, v209
  v_cvt_pk_bf16_f32 v41, v210, v211
  v_pk_fma_f32 v[204:205], v[156:157], v[160:161], v[4:5] op_sel_hi:[1,0,0]
  v_pk_fma_f32 v[206:207], v[158:159], v[160:161], v[4:5] op_sel_hi:[1,0,0]
  v_pk_fma_f32 v[204:205], v[100:101], v[140:141], v[204:205]
  v_pk_fma_f32 v[206:207], v[102:103], v[142:143], v[206:207]
  v_exp_f32 v208, v204
  v_exp_f32 v209, v205
  v_exp_f32 v210, v206
  v_exp_f32 v211, v207
  v_pk_fma_f32 v[208:209], v[208:209], v[6:7], v[8:9] op_sel_hi:[1,0,0]
  v_pk_fma_f32 v[210:211], v[210:211], v[6:7], v[8:9] op_sel_hi:[1,0,0]
  v_med3_f32 v208, v204, v208, v4
  v_med3_f32 v209, v205, v209, v4
  v_med3_f32 v210, v206, v210, v4
  v_med3_f32 v211, v207, v211, v4
  v_cvt_pk_bf16_f32 v42, v208, v209
  v_cvt_pk_bf16_f32 v43, v210, v211
  v_pk_fma_f32 v[204:205], v[144:145], v[162:163], v[4:5] op_sel_hi:[1,0,0]
  v_pk_fma_f32 v[206:207], v[146:147], v[162:163], v[4:5] op_sel_hi:[1,0,0]
  v_pk_fma_f32 v[204:205], v[20:21], v[128:129], v[204:205]
  v_pk_fma_f32 v[206:207], v[22:23], v[130:131], v[206:207]
  v_mfma_f32_16x16x32_bf16 v[172:175], v[36:39], v[216:219], 0
  v_exp_f32 v208, v204
  v_exp_f32 v209, v205
  v_mfma_f32_16x16x32_bf16 v[176:179], v[36:39], v[224:227], 0
  v_exp_f32 v210, v206
  v_exp_f32 v211, v207
  v_pk_fma_f32 v[208:209], v[208:209], v[6:7], v[8:9] op_sel_hi:[1,0,0]
  v_pk_fma_f32 v[210:211], v[210:211], v[6:7], v[8:9] op_sel_hi:[1,0,0]
  v_mfma_f32_16x16x32_bf16 v[180:183], v[36:39], v[232:235], 0
  v_med3_f32 v208, v204, v208, v4
  v_med3_f32 v209, v205, v209, v4
  v_med3_f32 v210, v206, v210, v4
  v_med3_f32 v211, v207, v211, v4
  v_cvt_pk_bf16_f32 v64, v208, v209
  v_cvt_pk_bf16_f32 v65, v210, v211
  v_pk_fma_f32 v[204:205], v[148:149], v[162:163], v[4:5] op_sel_hi:[1,0,0]
  v_pk_fma_f32 v[206:207], v[150:151], v[162:163], v[4:5] op_sel_hi:[1,0,0]
  v_pk_fma_f32 v[204:205], v[48:49], v[132:133], v[204:205]
  v_pk_fma_f32 v[206:207], v[50:51], v[134:135], v[206:207]
  v_mfma_f32_16x16x32_bf16 v[172:175], v[40:43], v[220:223], v[172:175]
  v_exp_f32 v208, v204
  v_exp_f32 v209, v205
  v_mfma_f32_16x16x32_bf16 v[176:179], v[40:43], v[228:231], v[176:179]
  v_exp_f32 v210, v206
  v_exp_f32 v211, v207
  v_pk_fma_f32 v[208:209], v[208:209], v[6:7], v[8:9] op_sel_hi:[1,0,0]
  v_pk_fma_f32 v[210:211], v[210:211], v[6:7], v[8:9] op_sel_hi:[1,0,0]
  v_mfma_f32_16x16x32_bf16 v[180:183], v[40:43], v[236:239], v[180:183]
  v_med3_f32 v208, v204, v208, v4
  v_med3_f32 v209, v205, v209, v4
  v_med3_f32 v210, v206, v210, v4
  v_med3_f32 v211, v207, v211, v4
  v_cvt_pk_bf16_f32 v66, v208, v209
  v_cvt_pk_bf16_f32 v67, v210, v211
  v_pk_fma_f32 v[204:205], v[152:153], v[162:163], v[4:5] op_sel_hi:[1,0,0]
  v_pk_fma_f32 v[206:207], v[154:155], v[162:163], v[4:5] op_sel_hi:[1,0,0]
  v_pk_fma_f32 v[204:205], v[76:77], v[136:137], v[204:205]
  v_pk_fma_f32 v[206:207], v[78:79], v[138:139], v[206:207]
  ds_write_b128 v255, v[172:175] offset:0
  v_exp_f32 v208, v204
  v_exp_f32 v209, v205
  ds_write_b128 v255, v[176:179] offset:1024
  v_exp_f32 v210, v206
  v_exp_f32 v211, v207
  v_pk_fma_f32 v[208:209], v[208:209], v[6:7], v[8:9] op_sel_hi:[1,0,0]
  v_pk_fma_f32 v[210:211], v[210:211], v[6:7], v[8:9] op_sel_hi:[1,0,0]
  ds_write_b128 v255, v[180:183] offset:2048
  v_med3_f32 v208, v204, v208, v4
  v_med3_f32 v209, v205, v209, v4
  v_med3_f32 v210, v206, v210, v4
  v_med3_f32 v211, v207, v211, v4
  v_cvt_pk_bf16_f32 v68, v208, v209
  v_cvt_pk_bf16_f32 v69, v210, v211
  v_pk_fma_f32 v[204:205], v[156:157], v[162:163], v[4:5] op_sel_hi:[1,0,0]
  v_pk_fma_f32 v[206:207], v[158:159], v[162:163], v[4:5] op_sel_hi:[1,0,0]
  v_pk_fma_f32 v[204:205], v[104:105], v[140:141], v[204:205]
  v_pk_fma_f32 v[206:207], v[106:107], v[142:143], v[206:207]
  v_exp_f32 v208, v204
  v_exp_f32 v209, v205
  v_exp_f32 v210, v206
  v_exp_f32 v211, v207
  v_pk_fma_f32 v[208:209], v[208:209], v[6:7], v[8:9] op_sel_hi:[1,0,0]
  v_pk_fma_f32 v[210:211], v[210:211], v[6:7], v[8:9] op_sel_hi:[1,0,0]
  v_med3_f32 v208, v204, v208, v4
  v_med3_f32 v209, v205, v209, v4
  v_med3_f32 v210, v206, v210, v4
  v_med3_f32 v211, v207, v211, v4
  v_cvt_pk_bf16_f32 v70, v208, v209
  v_cvt_pk_bf16_f32 v71, v210, v211
  v_pk_fma_f32 v[204:205], v[144:145], v[164:165], v[4:5] op_sel_hi:[1,0,0]
  v_pk_fma_f32 v[206:207], v[146:147], v[164:165], v[4:5] op_sel_hi:[1,0,0]
  v_pk_fma_f32 v[204:205], v[24:25], v[128:129], v[204:205]
  v_pk_fma_f32 v[206:207], v[26:27], v[130:131], v[206:207]
  v_mfma_f32_16x16x32_bf16 v[184:187], v[64:67], v[216:219], 0
  v_exp_f32 v208, v204
  v_exp_f32 v209, v205
  v_mfma_f32_16x16x32_bf16 v[188:191], v[64:67], v[224:227], 0
  v_exp_f32 v210, v206
  v_exp_f32 v211, v207
  v_pk_fma_f32 v[208:209], v[208:209], v[6:7], v[8:9] op_sel_hi:[1,0,0]
  v_pk_fma_f32 v[210:211], v[210:211], v[6:7], v[8:9] op_sel_hi:[1,0,0]
  v_mfma_f32_16x16x32_bf16 v[192:195], v[64:67], v[232:235], 0
  v_med3_f32 v208, v204, v208, v4
  v_med3_f32 v209, v205, v209, v4
  v_med3_f32 v210, v206, v210, v4
  v_med3_f32 v211, v207, v211, v4
  v_cvt_pk_bf16_f32 v92, v208, v209
  v_cvt_pk_bf16_f32 v93, v210, v211
  v_pk_fma_f32 v[204:205], v[148:149], v[164:165], v[4:5] op_sel_hi:[1,0,0]
  v_pk_fma_f32 v[206:207], v[150:151], v[164:165], v[4:5] op_sel_hi:[1,0,0]
  v_pk_fma_f32 v[204:205], v[52:53], v[132:133], v[204:205]
  v_pk_fma_f32 v[206:207], v[54:55], v[134:135], v[206:207]
  v_mfma_f32_16x16x32_bf16 v[184:187], v[68:71], v[220:223], v[184:187]
  v_exp_f32 v208, v204
  v_exp_f32 v209, v205
  v_mfma_f32_16x16x32_bf16 v[188:191], v[68:71], v[228:231], v[188:191]
  v_exp_f32 v210, v206
  v_exp_f32 v211, v207
  v_pk_fma_f32 v[208:209], v[208:209], v[6:7], v[8:9] op_sel_hi:[1,0,0]
  v_pk_fma_f32 v[210:211], v[210:211], v[6:7], v[8:9] op_sel_hi:[1,0,0]
  v_mfma_f32_16x16x32_bf16 v[192:195], v[68:71], v[236:239], v[192:195]
  v_med3_f32 v208, v204, v208, v4
  v_med3_f32 v209, v205, v209, v4
  v_med3_f32 v210, v206, v210, v4
  v_med3_f32 v211, v207, v211, v4
  v_cvt_pk_bf16_f32 v94, v208, v209
  v_cvt_pk_bf16_f32 v95, v210, v211
  v_pk_fma_f32 v[204:205], v[152:153], v[164:165], v[4:5] op_sel_hi:[1,0,0]
  v_pk_fma_f32 v[206:207], v[154:155], v[164:165], v[4:5] op_sel_hi:[1,0,0]
  v_pk_fma_f32 v[204:205], v[80:81], v[136:137], v[204:205]
  v_pk_fma_f32 v[206:207], v[82:83], v[138:139], v[206:207]
  ds_write_b128 v255, v[184:187] offset:3072
  v_exp_f32 v208, v204
  v_exp_f32 v209, v205
  ds_write_b128 v255, v[188:191] offset:4096
  v_exp_f32 v210, v206
  v_exp_f32 v211, v207
  v_pk_fma_f32 v[208:209], v[208:209], v[6:7], v[8:9] op_sel_hi:[1,0,0]
  v_pk_fma_f32 v[210:211], v[210:211], v[6:7], v[8:9] op_sel_hi:[1,0,0]
  ds_write_b128 v255, v[192:195] offset:5120
  v_med3_f32 v208, v204, v208, v4
  v_med3_f32 v209, v205, v209, v4
  v_med3_f32 v210, v206, v210, v4
  v_med3_f32 v211, v207, v211, v4
  v_cvt_pk_bf16_f32 v96, v208, v209
  v_cvt_pk_bf16_f32 v97, v210, v211
  v_pk_fma_f32 v[204:205], v[156:157], v[164:165], v[4:5] op_sel_hi:[1,0,0]
  v_pk_fma_f32 v[206:207], v[158:159], v[164:165], v[4:5] op_sel_hi:[1,0,0]
  v_pk_fma_f32 v[204:205], v[108:109], v[140:141], v[204:205]
  v_pk_fma_f32 v[206:207], v[110:111], v[142:143], v[206:207]
  v_exp_f32 v208, v204
  v_exp_f32 v209, v205
  v_exp_f32 v210, v206
  v_exp_f32 v211, v207
  v_pk_fma_f32 v[208:209], v[208:209], v[6:7], v[8:9] op_sel_hi:[1,0,0]
  v_pk_fma_f32 v[210:211], v[210:211], v[6:7], v[8:9] op_sel_hi:[1,0,0]
  v_med3_f32 v208, v204, v208, v4
  v_med3_f32 v209, v205, v209, v4
  v_med3_f32 v210, v206, v210, v4
  v_med3_f32 v211, v207, v211, v4
  v_cvt_pk_bf16_f32 v98, v208, v209
  v_cvt_pk_bf16_f32 v99, v210, v211
  v_mfma_f32_16x16x32_bf16 v[196:199], v[92:95], v[224:227], 0
  v_mfma_f32_16x16x32_bf16 v[200:203], v[92:95], v[232:235], 0
  v_mfma_f32_16x16x32_bf16 v[196:199], v[96:99], v[228:231], v[196:199]
  v_mfma_f32_16x16x32_bf16 v[200:203], v[96:99], v[236:239], v[200:203]
  s_nop 6
  ds_write_b128 v255, v[196:199] offset:6144
  ds_write_b128 v255, v[200:203] offset:7168
  s_waitcnt lgkmcnt(0)
  s_barrier
  s_nop 0
  ds_write_b64 v252, v[92:93] offset:0
  ds_write_b64 v252, v[94:95] offset:1920
  ds_write_b64 v252, v[96:97] offset:3840
  ds_write_b64 v252, v[98:99] offset:5760
  v_pk_fma_f32 v[204:205], v[144:145], v[166:167], v[4:5] op_sel_hi:[1,0,0]
  v_pk_fma_f32 v[206:207], v[146:147], v[166:167], v[4:5] op_sel_hi:[1,0,0]
  v_pk_fma_f32 v[204:205], v[28:29], v[128:129], v[204:205]
  v_pk_fma_f32 v[206:207], v[30:31], v[130:131], v[206:207]
  v_exp_f32 v208, v204
  v_exp_f32 v209, v205
  v_exp_f32 v210, v206
  v_exp_f32 v211, v207
  v_pk_fma_f32 v[208:209], v[208:209], v[6:7], v[8:9] op_sel_hi:[1,0,0]
  v_pk_fma_f32 v[210:211], v[210:211], v[6:7], v[8:9] op_sel_hi:[1,0,0]
  v_med3_f32 v208, v204, v208, v4
  v_med3_f32 v209, v205, v209, v4
  v_med3_f32 v210, v206, v210, v4
  v_med3_f32 v211, v207, v211, v4
  v_cvt_pk_bf16_f32 v216, v208, v209
  v_cvt_pk_bf16_f32 v217, v210, v211
  ds_write_b64 v252, v[216:217] offset:640
  v_pk_fma_f32 v[204:205], v[144:145], v[168:169], v[4:5] op_sel_hi:[1,0,0]
  v_pk_fma_f32 v[206:207], v[146:147], v[168:169], v[4:5] op_sel_hi:[1,0,0]
  v_pk_fma_f32 v[204:205], v[32:33], v[128:129], v[204:205]
  v_pk_fma_f32 v[206:207], v[34:35], v[130:131], v[206:207]
  v_exp_f32 v208, v204
  v_exp_f32 v209, v205
  v_exp_f32 v210, v206
  v_exp_f32 v211, v207
  v_pk_fma_f32 v[208:209], v[208:209], v[6:7], v[8:9] op_sel_hi:[1,0,0]
  v_pk_fma_f32 v[210:211], v[210:211], v[6:7], v[8:9] op_sel_hi:[1,0,0]
  v_med3_f32 v208, v204, v208, v4
  v_med3_f32 v209, v205, v209, v4
  v_med3_f32 v210, v206, v210, v4
  v_med3_f32 v211, v207, v211, v4
  v_cvt_pk_bf16_f32 v218, v208, v209
  v_cvt_pk_bf16_f32 v219, v210, v211
  ds_write_b64 v252, v[218:219] offset:1280
  v_pk_fma_f32 v[204:205], v[148:149], v[166:167], v[4:5] op_sel_hi:[1,0,0]
  v_pk_fma_f32 v[206:207], v[150:151], v[166:167], v[4:5] op_sel_hi:[1,0,0]
  v_pk_fma_f32 v[204:205], v[56:57], v[132:133], v[204:205]
  v_pk_fma_f32 v[206:207], v[58:59], v[134:135], v[206:207]
  v_exp_f32 v208, v204
  v_exp_f32 v209, v205
  v_exp_f32 v210, v206
  v_exp_f32 v211, v207
  v_pk_fma_f32 v[208:209], v[208:209], v[6:7], v[8:9] op_sel_hi:[1,0,0]
  v_pk_fma_f32 v[210:211], v[210:211], v[6:7], v[8:9] op_sel_hi:[1,0,0]
  v_med3_f32 v208, v204, v208, v4
  v_med3_f32 v209, v205, v209, v4
  v_med3_f32 v210, v206, v210, v4
  v_med3_f32 v211, v207, v211, v4
  v_cvt_pk_bf16_f32 v220, v208, v209
  v_cvt_pk_bf16_f32 v221, v210, v211
  ds_write_b64 v252, v[220:221] offset:2560
  v_pk_fma_f32 v[204:205], v[148:149], v[168:169], v[4:5] op_sel_hi:[1,0,0]
  v_pk_fma_f32 v[206:207], v[150:151], v[168:169], v[4:5] op_sel_hi:[1,0,0]
  v_pk_fma_f32 v[204:205], v[60:61], v[132:133], v[204:205]
  v_pk_fma_f32 v[206:207], v[62:63], v[134:135], v[206:207]
  v_exp_f32 v208, v204
  v_exp_f32 v209, v205
  v_exp_f32 v210, v206
  v_exp_f32 v211, v207
  v_pk_fma_f32 v[208:209], v[208:209], v[6:7], v[8:9] op_sel_hi:[1,0,0]
  v_pk_fma_f32 v[210:211], v[210:211], v[6:7], v[8:9] op_sel_hi:[1,0,0]
  v_med3_f32 v208, v204, v208, v4
  v_med3_f32 v209, v205, v209, v4
  v_med3_f32 v210, v206, v210, v4
  v_med3_f32 v211, v207, v211, v4
  v_cvt_pk_bf16_f32 v222, v208, v209
  v_cvt_pk_bf16_f32 v223, v210, v211
  ds_write_b64 v252, v[222:223] offset:3200
  v_pk_fma_f32 v[204:205], v[152:153], v[166:167], v[4:5] op_sel_hi:[1,0,0]
  v_pk_fma_f32 v[206:207], v[154:155], v[166:167], v[4:5] op_sel_hi:[1,0,0]
  v_pk_fma_f32 v[204:205], v[84:85], v[136:137], v[204:205]
  v_pk_fma_f32 v[206:207], v[86:87], v[138:139], v[206:207]
  v_exp_f32 v208, v204
  v_exp_f32 v209, v205
  v_exp_f32 v210, v206
  v_exp_f32 v211, v207
  v_pk_fma_f32 v[208:209], v[208:209], v[6:7], v[8:9] op_sel_hi:[1,0,0]
  v_pk_fma_f32 v[210:211], v[210:211], v[6:7], v[8:9] op_sel_hi:[1,0,0]
  v_med3_f32 v208, v204, v208, v4
  v_med3_f32 v209, v205, v209, v4
  v_med3_f32 v210, v206, v210, v4
  v_med3_f32 v211, v207, v211, v4
  v_cvt_pk_bf16_f32 v224, v208, v209
  v_cvt_pk_bf16_f32 v225, v210, v211
  ds_write_b64 v252, v[224:225] offset:4480
  v_pk_fma_f32 v[204:205], v[152:153], v[168:169], v[4:5] op_sel_hi:[1,0,0]
  v_pk_fma_f32 v[206:207], v[154:155], v[168:169], v[4:5] op_sel_hi:[1,0,0]
  v_pk_fma_f32 v[204:205], v[88:89], v[136:137], v[204:205]
  v_pk_fma_f32 v[206:207], v[90:91], v[138:139], v[206:207]
  v_exp_f32 v208, v204
  v_exp_f32 v209, v205
  v_exp_f32 v210, v206
  v_exp_f32 v211, v207
  v_pk_fma_f32 v[208:209], v[208:209], v[6:7], v[8:9] op_sel_hi:[1,0,0]
  v_pk_fma_f32 v[210:211], v[210:211], v[6:7], v[8:9] op_sel_hi:[1,0,0]
  v_med3_f32 v208, v204, v208, v4
  v_med3_f32 v209, v205, v209, v4
  v_med3_f32 v210, v206, v210, v4
  v_med3_f32 v211, v207, v211, v4
  v_cvt_pk_bf16_f32 v226, v208, v209
  v_cvt_pk_bf16_f32 v227, v210, v211
  ds_write_b64 v252, v[226:227] offset:5120
  v_pk_fma_f32 v[204:205], v[156:157], v[166:167], v[4:5] op_sel_hi:[1,0,0]
  v_pk_fma_f32 v[206:207], v[158:159], v[166:167], v[4:5] op_sel_hi:[1,0,0]
  v_pk_fma_f32 v[204:205], v[112:113], v[140:141], v[204:205]
  v_pk_fma_f32 v[206:207], v[114:115], v[142:143], v[206:207]
  v_exp_f32 v208, v204
  v_exp_f32 v209, v205
  v_exp_f32 v210, v206
  v_exp_f32 v211, v207
  v_pk_fma_f32 v[208:209], v[208:209], v[6:7], v[8:9] op_sel_hi:[1,0,0]
  v_pk_fma_f32 v[210:211], v[210:211], v[6:7], v[8:9] op_sel_hi:[1,0,0]
  v_med3_f32 v208, v204, v208, v4
  v_med3_f32 v209, v205, v209, v4
  v_med3_f32 v210, v206, v210, v4
  v_med3_f32 v211, v207, v211, v4
  v_cvt_pk_bf16_f32 v228, v208, v209
  v_cvt_pk_bf16_f32 v229, v210, v211
  ds_write_b64 v252, v[228:229] offset:6400
  v_pk_fma_f32 v[204:205], v[156:157], v[168:169], v[4:5] op_sel_hi:[1,0,0]
  v_pk_fma_f32 v[206:207], v[158:159], v[168:169], v[4:5] op_sel_hi:[1,0,0]
  v_pk_fma_f32 v[204:205], v[116:117], v[140:141], v[204:205]
  v_pk_fma_f32 v[206:207], v[118:119], v[142:143], v[206:207]
  v_exp_f32 v208, v204
  v_exp_f32 v209, v205
  v_exp_f32 v210, v206
  v_exp_f32 v211, v207
  v_pk_fma_f32 v[208:209], v[208:209], v[6:7], v[8:9] op_sel_hi:[1,0,0]
  v_pk_fma_f32 v[210:211], v[210:211], v[6:7], v[8:9] op_sel_hi:[1,0,0]
  v_med3_f32 v208, v204, v208, v4
  v_med3_f32 v209, v205, v209, v4
  v_med3_f32 v210, v206, v210, v4
  v_med3_f32 v211, v207, v211, v4
  v_cvt_pk_bf16_f32 v230, v208, v209
  v_cvt_pk_bf16_f32 v231, v210, v211
  ds_write_b64 v252, v[230:231] offset:7040
  s_waitcnt lgkmcnt(0)
  s_nop 0
  ds_read_b64_tr_b16 v[16:17], v253 offset:160
  ds_read_b64_tr_b16 v[18:19], v253 offset:800
  ds_read_b64_tr_b16 v[20:21], v254 offset:1440
  ds_read_b64_tr_b16 v[22:23], v253 offset:2080
  ds_read_b64_tr_b16 v[24:25], v253 offset:2720
  ds_read_b64_tr_b16 v[26:27], v254 offset:3360
  ds_read_b64_tr_b16 v[28:29], v253 offset:4000
  ds_read_b64_tr_b16 v[30:31], v253 offset:4640
  ds_read_b64_tr_b16 v[32:33], v254 offset:5280
  ds_read_b64_tr_b16 v[34:35], v253 offset:5920
  ds_read_b64_tr_b16 v[36:37], v253 offset:6560
  ds_read_b64_tr_b16 v[38:39], v254 offset:7200
  v_lshlrev_b32_e64 v2, 2, v1
  v_add_u32 v2, 159616, v2
  ds_read_b32 v240, v2 offset:0
  ds_read_b32 v241, v2 offset:256
  ds_read_b32 v242, v2 offset:512
  ds_read_b32 v243, v2 offset:768
  ds_read_b32 v244, v2 offset:1024
  ds_read_b32 v245, v2 offset:1280
  ds_read_b32 v246, v2 offset:1536
  ds_read_b32 v247, v2 offset:1792
  ds_read_b32 v248, v2 offset:2048
  v_mov_b32 v40, 0
  v_mov_b32 v41, 0
  v_mov_b32 v50, 0
  v_mov_b32 v51, 0
  v_mov_b32 v58, 0
  v_mov_b32 v59, 0
  v_mov_b32 v66, 0
  v_mov_b32 v67, 0
  v_lshlrev_b32 v6, 4, v1
  v_lshlrev_b32 v7, 4, v13
  v_lshl_add_u32 v7, v14, 1, v7
  s_xor_b32 s57, s48, 1
  s_lshr_b32 s58, s57, 1
  s_lshl_b32 s58, s58, 8
  s_and_b32 s59, s57, 1
  s_lshl_b32 s59, s59, 3
  s_add_u32 s58, s58, s59
  s_add_u32 s58, s58, 16384
  v_add_u32 v7, s58, v7
  s_lshl_b32 s57, s57, 10
  v_add_u32 v6, s57, v6
  v_and_b32 v8, 1, v14
  v_lshl_or_b32 v7, v8, 31, v7
  v_mov_b32 v9, 0x3f317218
  v_mov_b32 v10, 0x358637bd
  v_mov_b32 v8, v2
  s_lshl_b32 s55, s50, 4
  s_lshl_b32 s56, s54, 2
  s_add_u32 s55, s55, s56
  s_mul_i32 s55, s55, 18432
  s_add_u32 s55, s55, 393216
  s_waitcnt lgkmcnt(0)
  s_cmp_ge_u32 s53, 9
  s_cselect_b32 s57, 9, 0
  s_cselect_b32 s58, 8, 0
  s_sub_u32 s63, s53, s57
  s_lshl_b32 s60, s26, 4
  s_add_u32 s60, s60, s58
  s_add_u32 s60, s60, s3
  s_mul_i32 s61, s60, 18432
  s_add_u32 s62, s61, 393216
  s_lshl_b32 s57, s63, 7
  s_add_u32 s61, s61, s57
  s_mul_i32 s50, s3, 4608
  s_add_u32 s50, s50, 73728
  s_mul_i32 s51, s60, 2304
  s_add_u32 s51, s51, 2752512
  s_lshl_b32 s52, s63, 8
  s_add_u32 s52, s52, s51
  s_mov_b32 s44, 0x00f0000f
  s_mov_b32 s45, 0xf0000f00
  s_mov_b32 s46, 0x22222222
  s_mov_b32 s47, 0x22222222
  s_mov_b32 s48, 0xcccccccc
  s_mov_b32 s49, 0xcccccccc
  s_mov_b32 s42, 0x88888888
  s_mov_b32 s43, 0x88888888
  v_lshlrev_b32 v249, 4, v13
  v_lshrrev_b32_e64 v252, 3, v1
  s_barrier
  ds_read_b64 v[60:61], v246
  ds_read_b64 v[62:63], v247
  ds_read_b64 v[64:65], v248
  ds_read_b64 v[44:45], v240
  ds_read_b64 v[46:47], v241
  ds_read_b64 v[48:49], v242
  ds_read_b64 v[52:53], v243
  ds_read_b64 v[54:55], v244
  ds_read_b64 v[56:57], v245
  s_waitcnt lgkmcnt(6)
  s_nop 0
  v_mfma_f32_16x16x32_bf16 v[76:79], v[60:63], v[16:19], 0
  v_mfma_f32_16x16x32_bf16 v[88:91], v[60:63], v[22:25], 0
  v_mfma_f32_16x16x32_bf16 v[100:103], v[60:63], v[28:31], 0
  v_mfma_f32_16x16x32_bf16 v[112:115], v[60:63], v[34:37], 0
  v_mfma_f32_16x16x32_bf16 v[76:79], v[64:67], v[20:23], v[76:79]
  v_mfma_f32_16x16x32_bf16 v[88:91], v[64:67], v[26:29], v[88:91]
  v_mfma_f32_16x16x32_bf16 v[100:103], v[64:67], v[32:35], v[100:103]
  v_mfma_f32_16x16x32_bf16 v[112:115], v[64:67], v[38:41], v[112:115]
  s_waitcnt lgkmcnt(0)
  s_nop 0
  v_mfma_f32_16x16x32_bf16 v[68:71], v[44:47], v[16:19], 0
  v_mfma_f32_16x16x32_bf16 v[72:75], v[52:55], v[16:19], 0
  v_mfma_f32_16x16x32_bf16 v[68:71], v[48:51], v[20:23], v[68:71]
  v_mfma_f32_16x16x32_bf16 v[72:75], v[56:59], v[20:23], v[72:75]
  v_mul_f32 v78, v9, v78
  v_mul_f32 v90, v9, v90
  v_mfma_f32_16x16x32_bf16 v[80:83], v[44:47], v[22:25], 0
  v_mul_f32 v102, v9, v102
  v_mul_f32 v114, v9, v114
  v_mfma_f32_16x16x32_bf16 v[84:87], v[52:55], v[22:25], 0
  v_cvt_pk_bf16_f32 v78, v78, v78
  v_cvt_pk_bf16_f32 v90, v90, v90
  v_mfma_f32_16x16x32_bf16 v[80:83], v[48:51], v[26:29], v[80:83]
  v_cvt_pk_bf16_f32 v102, v102, v102
  v_cvt_pk_bf16_f32 v114, v114, v114
  v_mfma_f32_16x16x32_bf16 v[84:87], v[56:59], v[26:29], v[84:87]
  v_and_b32 v78, 0xffff0000, v78
  v_and_b32 v90, 0xffff0000, v90
  v_mfma_f32_16x16x32_bf16 v[92:95], v[44:47], v[28:31], 0
  v_and_b32 v102, 0xffff0000, v102
  v_and_b32 v114, 0xffff0000, v114
  v_mfma_f32_16x16x32_bf16 v[96:99], v[52:55], v[28:31], 0
  v_add_f32 v78, v10, v78
  v_add_f32 v90, v10, v90
  v_mfma_f32_16x16x32_bf16 v[92:95], v[48:51], v[32:35], v[92:95]
  v_add_f32 v102, v10, v102
  v_add_f32 v114, v10, v114
  v_mfma_f32_16x16x32_bf16 v[96:99], v[56:59], v[32:35], v[96:99]
  v_rcp_f32 v78, v78
  v_rcp_f32 v90, v90
  v_mfma_f32_16x16x32_bf16 v[104:107], v[44:47], v[34:37], 0
  v_rcp_f32 v102, v102
  v_rcp_f32 v114, v114
  v_mfma_f32_16x16x32_bf16 v[108:111], v[52:55], v[34:37], 0
  v_mul_f32 v78, v9, v78
  v_mul_f32 v90, v9, v90
  v_mfma_f32_16x16x32_bf16 v[104:107], v[48:51], v[38:41], v[104:107]
  v_mul_f32 v102, v9, v102
  v_mul_f32 v114, v9, v114
  v_mfma_f32_16x16x32_bf16 v[108:111], v[56:59], v[38:41], v[108:111]
  v_pk_mul_f32 v[68:69], v[68:69], v[78:79] op_sel_hi:[1,0]
  v_pk_mul_f32 v[70:71], v[70:71], v[78:79] op_sel_hi:[1,0]
  v_pk_mul_f32 v[72:73], v[72:73], v[78:79] op_sel_hi:[1,0]
  v_pk_mul_f32 v[74:75], v[74:75], v[78:79] op_sel_hi:[1,0]
  v_pk_mul_f32 v[76:77], v[76:77], v[78:79] op_sel_hi:[1,0]
  v_cvt_pk_bf16_f32 v68, v68, v69
  v_cvt_pk_bf16_f32 v69, v70, v71
  v_cvt_pk_bf16_f32 v70, v72, v73
  v_cvt_pk_bf16_f32 v71, v74, v75
  v_cvt_pk_bf16_f32 v72, v76, v77
  buffer_store_dwordx4 v[68:71], v6, s[36:39], s55 offen sc1
  buffer_store_dword v72, v7, s[36:39], s55 offen sc1
  s_add_u32 s55, s55, 18432
  v_pk_mul_f32 v[80:81], v[80:81], v[90:91] op_sel_hi:[1,0]
  v_pk_mul_f32 v[82:83], v[82:83], v[90:91] op_sel_hi:[1,0]
  v_pk_mul_f32 v[84:85], v[84:85], v[90:91] op_sel_hi:[1,0]
  v_pk_mul_f32 v[86:87], v[86:87], v[90:91] op_sel_hi:[1,0]
  v_pk_mul_f32 v[88:89], v[88:89], v[90:91] op_sel_hi:[1,0]
  v_cvt_pk_bf16_f32 v80, v80, v81
  v_cvt_pk_bf16_f32 v81, v82, v83
  v_cvt_pk_bf16_f32 v82, v84, v85
  v_cvt_pk_bf16_f32 v83, v86, v87
  v_cvt_pk_bf16_f32 v84, v88, v89
  buffer_store_dwordx4 v[80:83], v6, s[36:39], s55 offen sc1
  buffer_store_dword v84, v7, s[36:39], s55 offen sc1
  s_add_u32 s55, s55, 18432
  v_pk_mul_f32 v[92:93], v[92:93], v[102:103] op_sel_hi:[1,0]
  v_pk_mul_f32 v[94:95], v[94:95], v[102:103] op_sel_hi:[1,0]
  v_pk_mul_f32 v[96:97], v[96:97], v[102:103] op_sel_hi:[1,0]
  v_pk_mul_f32 v[98:99], v[98:99], v[102:103] op_sel_hi:[1,0]
  v_pk_mul_f32 v[100:101], v[100:101], v[102:103] op_sel_hi:[1,0]
  v_cvt_pk_bf16_f32 v92, v92, v93
  v_cvt_pk_bf16_f32 v93, v94, v95
  v_cvt_pk_bf16_f32 v94, v96, v97
  v_cvt_pk_bf16_f32 v95, v98, v99
  v_cvt_pk_bf16_f32 v96, v100, v101
  buffer_store_dwordx4 v[92:95], v6, s[36:39], s55 offen sc1
  buffer_store_dword v96, v7, s[36:39], s55 offen sc1
  s_add_u32 s55, s55, 18432
  v_pk_mul_f32 v[104:105], v[104:105], v[114:115] op_sel_hi:[1,0]
  v_pk_mul_f32 v[106:107], v[106:107], v[114:115] op_sel_hi:[1,0]
  v_pk_mul_f32 v[108:109], v[108:109], v[114:115] op_sel_hi:[1,0]
  v_pk_mul_f32 v[110:111], v[110:111], v[114:115] op_sel_hi:[1,0]
  v_pk_mul_f32 v[112:113], v[112:113], v[114:115] op_sel_hi:[1,0]
  v_cvt_pk_bf16_f32 v104, v104, v105
  v_cvt_pk_bf16_f32 v105, v106, v107
  v_cvt_pk_bf16_f32 v106, v108, v109
  v_cvt_pk_bf16_f32 v107, v110, v111
  v_cvt_pk_bf16_f32 v108, v112, v113
  buffer_store_dwordx4 v[104:107], v6, s[36:39], s55 offen sc1
  buffer_store_dword v108, v7, s[36:39], s55 offen sc1
  s_mov_b32 s33, 0
  s_branch L_s3a
L_s3pre:
  s_cmp_ge_u32 s53, 9
  s_cselect_b32 s57, 9, 0
  s_cselect_b32 s58, 8, 0
  s_sub_u32 s63, s53, s57
  s_lshl_b32 s60, s26, 4
  s_add_u32 s60, s60, s58
  s_add_u32 s60, s60, s3
  s_mul_i32 s61, s60, 18432
  s_add_u32 s62, s61, 393216
  s_lshl_b32 s57, s63, 7
  s_add_u32 s61, s61, s57
  s_nop 0
  s_mul_i32 s50, s3, 4608
  s_add_u32 s50, s50, 73728
  s_mul_i32 s51, s60, 2304
  s_add_u32 s51, s51, 2752512
  s_lshl_b32 s52, s63, 8
  s_add_u32 s52, s52, s51
  s_mov_b32 s44, 0x00f0000f
  s_mov_b32 s45, 0xf0000f00
  s_mov_b32 s46, 0x22222222
  s_mov_b32 s47, 0x22222222
  s_mov_b32 s48, 0xcccccccc
  s_mov_b32 s49, 0xcccccccc
  s_mov_b32 s42, 0x88888888
  s_mov_b32 s43, 0x88888888
  v_lshlrev_b32 v249, 4, v13
  v_lshrrev_b32 v252, 3, v1
  v_lshrrev_b32_e64 v2, 2, v13
  v_lshl_add_u32 v2, v14, 2, v2
  v_bfe_u32 v3, v2, 1, 2
  v_lshlrev_b32 v2, 7, v2
  v_and_b32 v4, 3, v13
  v_lshl_add_u32 v2, v4, 3, v2
  v_lshl_add_u32 v236, v3, 5, v2
  v_xor_b32 v237, 32, v236
  v_xor_b32 v238, 64, v236
  v_xor_b32 v239, 96, v236
  s_lshl_b32 s57, s63, 7
  s_add_u32 s57, s57, 158272
  v_lshl_add_u32 v113, v14, 3, s57
  v_lshrrev_b32 v2, 1, v14
  v_and_b32 v3, 7, v13
  v_xor_b32 v2, v2, v3
  v_lshlrev_b32_e64 v2, 4, v2
  v_lshl_add_u32 v2, v13, 7, v2
  v_and_b32_e64 v3, 1, v14
  v_lshl_add_u32 v2, v3, 3, v2
  s_lshl_b32 s57, s3, 11
  s_add_u32 s57, s57, 137216
  v_add_u32 v112, s57, v2
  v_and_b32_e64 v2, 3, v13
  v_cmp_eq_u32 s[40:41], 2, v2
  s_nop 1
  s_nop 0
  v_cndmask_b32_e64 v114, 0, -1, s[40:41]
  v_mov_b32 v4, 0x3f803f80
  v_cmp_eq_u32 s[40:41], 0, v2
  s_nop 1
  s_nop 0
  v_cndmask_b32_e64 v115, 0, v4, s[40:41]
  v_mul_u32_u24 v250, 144, v13
  v_lshl_add_u32 v250, v14, 3, v250
  v_add_u32 v250, s50, v250
  v_add_u32 v251, v252, v1
  v_lshl_add_u32 v251, v251, 4, s50
  v_mul_u32_u24 v252, 1152, v252
  v_and_b32_e64 v253, 7, v1
  v_lshl_add_u32 v252, v253, 4, v252
  v_lshl_add_u32 v254, s60, 4, v13
  v_sub_u32 v254, 2047, v254
  s_lshl_b32 s57, s3, 3
  s_add_u32 s57, s57, 159552
  v_mov_b32 v11, s57
  v_lshlrev_b32_e64 v5, 2, v13
  v_add_u32 v5, 159552, v5
L_s3rd:
  v_xor_b32_e64 v4, 0, v112
  ds_read_b64 v[240:241], v4
  ds_read_b64 v[132:133], v113 offset:0
  v_xor_b32_e64 v4, 32, v112
  ds_read_b64 v[242:243], v4
  ds_read_b64 v[134:135], v113 offset:32
  v_xor_b32_e64 v4, 64, v112
  ds_read_b64 v[244:245], v4
  ds_read_b64 v[136:137], v113 offset:64
  v_xor_b32 v4, 96, v112
  ds_read_b64 v[246:247], v4
  ds_read_b64 v[138:139], v113 offset:96
  v_mov_b32 v2, 158208
  ds_read_b32 v255, v2
  ds_read_b64_tr_b16 v[140:141], v236 offset:0
  ds_read_b64_tr_b16 v[142:143], v236 offset:2048
  ds_read_b64_tr_b16 v[144:145], v237 offset:0
  ds_read_b64_tr_b16 v[146:147], v237 offset:2048
  ds_read_b64_tr_b16 v[148:149], v238 offset:0
  ds_read_b64_tr_b16 v[150:151], v238 offset:2048
  ds_read_b64_tr_b16 v[152:153], v239 offset:0
  ds_read_b64_tr_b16 v[154:155], v239 offset:2048
  ds_read_b64_tr_b16 v[156:157], v236 offset:4096
  ds_read_b64_tr_b16 v[158:159], v236 offset:6144
  ds_read_b64_tr_b16 v[160:161], v237 offset:4096
  ds_read_b64_tr_b16 v[162:163], v237 offset:6144
  ds_read_b64_tr_b16 v[164:165], v238 offset:4096
  ds_read_b64_tr_b16 v[166:167], v238 offset:6144
  ds_read_b64_tr_b16 v[168:169], v239 offset:4096
  ds_read_b64_tr_b16 v[170:171], v239 offset:6144
  ds_read_b64_tr_b16 v[172:173], v236 offset:8192
  ds_read_b64_tr_b16 v[174:175], v236 offset:10240
  ds_read_b64_tr_b16 v[176:177], v237 offset:8192
  ds_read_b64_tr_b16 v[178:179], v237 offset:10240
  ds_read_b64_tr_b16 v[180:181], v238 offset:8192
  ds_read_b64_tr_b16 v[182:183], v238 offset:10240
  ds_read_b64_tr_b16 v[184:185], v239 offset:8192
  ds_read_b64_tr_b16 v[186:187], v239 offset:10240
  ds_read_b64_tr_b16 v[188:189], v236 offset:12288
  ds_read_b64_tr_b16 v[190:191], v236 offset:14336
  ds_read_b64_tr_b16 v[192:193], v237 offset:12288
  ds_read_b64_tr_b16 v[194:195], v237 offset:14336
  ds_read_b64_tr_b16 v[196:197], v238 offset:12288
  ds_read_b64_tr_b16 v[198:199], v238 offset:14336
  ds_read_b64_tr_b16 v[200:201], v239 offset:12288
  ds_read_b64_tr_b16 v[202:203], v239 offset:14336
  ds_read_b64_tr_b16 v[204:205], v236 offset:16384
  ds_read_b64_tr_b16 v[206:207], v236 offset:18432
  ds_read_b64_tr_b16 v[208:209], v237 offset:16384
  ds_read_b64_tr_b16 v[210:211], v237 offset:18432
  ds_read_b64_tr_b16 v[212:213], v238 offset:16384
  ds_read_b64_tr_b16 v[214:215], v238 offset:18432
  ds_read_b64_tr_b16 v[216:217], v239 offset:16384
  ds_read_b64_tr_b16 v[218:219], v239 offset:18432
  ds_read_b64_tr_b16 v[220:221], v236 offset:20480
  ds_read_b64_tr_b16 v[222:223], v236 offset:22528
  ds_read_b64_tr_b16 v[224:225], v237 offset:20480
  ds_read_b64_tr_b16 v[226:227], v237 offset:22528
  ds_read_b64_tr_b16 v[228:229], v238 offset:20480
  ds_read_b64_tr_b16 v[230:231], v238 offset:22528
  ds_read_b64_tr_b16 v[232:233], v239 offset:20480
  ds_read_b64_tr_b16 v[234:235], v239 offset:22528
L_s3un:
  s_mov_b32 s33, 1
  s_waitcnt lgkmcnt(15)
  v_lshlrev_b32_e64 v116, 16, v240
  v_and_b32 v117, 0xffff0000, v240
  v_and_or_b32 v132, v132, v114, v115
  v_lshlrev_b32_e64 v118, 16, v241
  v_and_b32 v119, 0xffff0000, v241
  v_and_or_b32 v133, v133, v114, v115
  v_lshlrev_b32_e64 v120, 16, v242
  v_and_b32 v121, 0xffff0000, v242
  v_and_or_b32 v134, v134, v114, v115
  v_lshlrev_b32_e64 v122, 16, v243
  v_and_b32 v123, 0xffff0000, v243
  v_and_or_b32 v135, v135, v114, v115
  v_lshlrev_b32_e64 v124, 16, v244
  v_and_b32 v125, 0xffff0000, v244
  v_and_or_b32 v136, v136, v114, v115
  v_lshlrev_b32_e64 v126, 16, v245
  v_and_b32 v127, 0xffff0000, v245
  v_and_or_b32 v137, v137, v114, v115
  v_lshlrev_b32_e64 v128, 16, v246
  v_and_b32 v129, 0xffff0000, v246
  v_and_or_b32 v138, v138, v114, v115
  v_lshlrev_b32_e64 v130, 16, v247
  v_and_b32 v131, 0xffff0000, v247
  v_and_or_b32 v139, v139, v114, v115
L_s3a:
  v_lshlrev_b32 v6, 4, v1
  s_mov_b32 s35, 0
  s_mul_i32 s56, s63, 0
  s_cmp_lt_u32 s27, 16
  s_cbranch_scc1 L_oload
  s_cmp_lg_u32 s3, 7
  s_cbranch_scc1 L_oload
  v_mov_b32_e64 v2, 0
  s_mov_b32 s59, 0
  s_add_u32 s57, s62, 1024
L_ohint:
  s_sleep 2
  buffer_load_dword v3, v2, s[36:39], s57 offen offset:1020 sc1
  s_waitcnt vmcnt(0)
  v_cmp_eq_u32_e64 vcc, -1, v3
  s_cbranch_vccz L_oload
  s_add_u32 s59, s59, 1
  s_cmp_lt_u32 s59, 131072
  s_cbranch_scc1 L_ohint
L_oload:
  s_waitcnt vmcnt(0) lgkmcnt(0)
  s_barrier
  s_lshr_b32 s57, s60, 3
  s_lshl_b32 s57, s57, 7
  s_add_u32 s57, s57, 3065856
  v_min_u32 v8, 8, v1
  v_lshlrev_b32_e64 v8, 2, v8
  buffer_load_dword v15, v8, s[36:39], s57 offen sc1
  s_getreg_b32 s53, hwreg(HW_REG_XCC_ID)
  s_and_b32 s53, s53, 15
L_redo:
  s_add_u32 s57, s62, 0
  s_nop 0
  buffer_load_dwordx4 v[16:19], v6, s[36:39], s57 offen offset:0 sc1
  buffer_load_dwordx4 v[20:23], v6, s[36:39], s57 offen offset:1024 sc1
  s_add_u32 s57, s62, 2048
  buffer_load_dwordx4 v[24:27], v6, s[36:39], s57 offen offset:0 sc1
  buffer_load_dwordx4 v[28:31], v6, s[36:39], s57 offen offset:1024 sc1
  s_add_u32 s57, s62, 4096
  buffer_load_dwordx4 v[32:35], v6, s[36:39], s57 offen offset:0 sc1
  buffer_load_dwordx4 v[36:39], v6, s[36:39], s57 offen offset:1024 sc1
  s_cmp_eq_u32 s33, 0
  s_cbranch_scc0 L_s3b
  v_lshrrev_b32_e64 v2, 2, v13
  v_lshl_add_u32 v2, v14, 2, v2
  v_bfe_u32 v3, v2, 1, 2
  v_lshlrev_b32 v2, 7, v2
  v_and_b32 v4, 3, v13
  v_lshl_add_u32 v2, v4, 3, v2
  v_lshl_add_u32 v236, v3, 5, v2
  v_xor_b32 v237, 32, v236
  v_xor_b32 v238, 64, v236
  v_xor_b32 v239, 96, v236
  s_lshl_b32 s57, s63, 7
  s_add_u32 s57, s57, 158272
  v_lshl_add_u32 v113, v14, 3, s57
  v_lshrrev_b32 v2, 1, v14
  v_and_b32 v3, 7, v13
  v_xor_b32 v2, v2, v3
  v_lshlrev_b32_e64 v2, 4, v2
  v_lshl_add_u32 v2, v13, 7, v2
  v_and_b32_e64 v3, 1, v14
  v_lshl_add_u32 v2, v3, 3, v2
  s_lshl_b32 s57, s3, 11
  s_add_u32 s57, s57, 137216
  v_add_u32 v112, s57, v2
  v_xor_b32_e64 v4, 0, v112
  ds_read_b64 v[240:241], v4
  ds_read_b64 v[132:133], v113 offset:0
  v_xor_b32_e64 v4, 32, v112
  ds_read_b64 v[242:243], v4
  ds_read_b64 v[134:135], v113 offset:32
  v_xor_b32_e64 v4, 64, v112
  ds_read_b64 v[244:245], v4
  ds_read_b64 v[136:137], v113 offset:64
  v_xor_b32 v4, 96, v112
  ds_read_b64 v[246:247], v4
  ds_read_b64 v[138:139], v113 offset:96
  v_mov_b32 v2, 158208
  ds_read_b32 v255, v2
  ds_read_b64_tr_b16 v[140:141], v236 offset:0
  ds_read_b64_tr_b16 v[142:143], v236 offset:2048
  ds_read_b64_tr_b16 v[144:145], v237 offset:0
  ds_read_b64_tr_b16 v[146:147], v237 offset:2048
  ds_read_b64_tr_b16 v[148:149], v238 offset:0
  ds_read_b64_tr_b16 v[150:151], v238 offset:2048
  ds_read_b64_tr_b16 v[152:153], v239 offset:0
  ds_read_b64_tr_b16 v[154:155], v239 offset:2048
  ds_read_b64_tr_b16 v[156:157], v236 offset:4096
  ds_read_b64_tr_b16 v[158:159], v236 offset:6144
  ds_read_b64_tr_b16 v[160:161], v237 offset:4096
  ds_read_b64_tr_b16 v[162:163], v237 offset:6144
  ds_read_b64_tr_b16 v[164:165], v238 offset:4096
  ds_read_b64_tr_b16 v[166:167], v238 offset:6144
  ds_read_b64_tr_b16 v[168:169], v239 offset:4096
  ds_read_b64_tr_b16 v[170:171], v239 offset:6144
  ds_read_b64_tr_b16 v[172:173], v236 offset:8192
  ds_read_b64_tr_b16 v[174:175], v236 offset:10240
  ds_read_b64_tr_b16 v[176:177], v237 offset:8192
  ds_read_b64_tr_b16 v[178:179], v237 offset:10240
  ds_read_b64_tr_b16 v[180:181], v238 offset:8192
  ds_read_b64_tr_b16 v[182:183], v238 offset:10240
  ds_read_b64_tr_b16 v[184:185], v239 offset:8192
  ds_read_b64_tr_b16 v[186:187], v239 offset:10240
  ds_read_b64_tr_b16 v[188:189], v236 offset:12288
  ds_read_b64_tr_b16 v[190:191], v236 offset:14336
  ds_read_b64_tr_b16 v[192:193], v237 offset:12288
  ds_read_b64_tr_b16 v[194:195], v237 offset:14336
  ds_read_b64_tr_b16 v[196:197], v238 offset:12288
  ds_read_b64_tr_b16 v[198:199], v238 offset:14336
  ds_read_b64_tr_b16 v[200:201], v239 offset:12288
  ds_read_b64_tr_b16 v[202:203], v239 offset:14336
  ds_read_b64_tr_b16 v[204:205], v236 offset:16384
  ds_read_b64_tr_b16 v[206:207], v236 offset:18432
  ds_read_b64_tr_b16 v[208:209], v237 offset:16384
  ds_read_b64_tr_b16 v[210:211], v237 offset:18432
  ds_read_b64_tr_b16 v[212:213], v238 offset:16384
  ds_read_b64_tr_b16 v[214:215], v238 offset:18432
  ds_read_b64_tr_b16 v[216:217], v239 offset:16384
  ds_read_b64_tr_b16 v[218:219], v239 offset:18432
  ds_read_b64_tr_b16 v[220:221], v236 offset:20480
  ds_read_b64_tr_b16 v[222:223], v236 offset:22528
  ds_read_b64_tr_b16 v[224:225], v237 offset:20480
  ds_read_b64_tr_b16 v[226:227], v237 offset:22528
  ds_read_b64_tr_b16 v[228:229], v238 offset:20480
  ds_read_b64_tr_b16 v[230:231], v238 offset:22528
  ds_read_b64_tr_b16 v[232:233], v239 offset:20480
  ds_read_b64_tr_b16 v[234:235], v239 offset:22528
  v_and_b32_e64 v2, 3, v13
  v_cmp_eq_u32 s[40:41], 2, v2
  s_nop 1
  s_nop 0
  v_cndmask_b32_e64 v114, 0, -1, s[40:41]
  v_mov_b32 v4, 0x3f803f80
  v_cmp_eq_u32 s[40:41], 0, v2
  s_nop 1
  s_nop 0
  v_cndmask_b32_e64 v115, 0, v4, s[40:41]
  v_mul_u32_u24 v250, 144, v13
  v_lshl_add_u32 v250, v14, 3, v250
  v_add_u32 v250, s50, v250
  v_add_u32 v251, v252, v1
  v_lshl_add_u32 v251, v251, 4, s50
  v_mul_u32_u24 v252, 1152, v252
  v_and_b32_e64 v253, 7, v1
  v_lshl_add_u32 v252, v253, 4, v252
  v_lshl_add_u32 v254, s60, 4, v13
  v_sub_u32 v254, 2047, v254
  s_lshl_b32 s57, s3, 3
  s_add_u32 s57, s57, 159552
  v_mov_b32 v11, s57
  v_lshlrev_b32_e64 v5, 2, v13
  v_add_u32 v5, 159552, v5
  s_waitcnt lgkmcnt(15)
  v_lshlrev_b32 v116, 16, v240
  v_and_b32 v117, 0xffff0000, v240
  v_and_or_b32 v132, v132, v114, v115
  v_lshlrev_b32_e64 v118, 16, v241
  v_and_b32 v119, 0xffff0000, v241
  v_and_or_b32 v133, v133, v114, v115
  v_lshlrev_b32_e64 v120, 16, v242
  v_and_b32 v121, 0xffff0000, v242
  v_and_or_b32 v134, v134, v114, v115
  v_lshlrev_b32_e64 v122, 16, v243
  v_and_b32 v123, 0xffff0000, v243
  v_and_or_b32 v135, v135, v114, v115
  v_lshlrev_b32_e64 v124, 16, v244
  v_and_b32 v125, 0xffff0000, v244
  v_and_or_b32 v136, v136, v114, v115
  v_lshlrev_b32_e64 v126, 16, v245
  v_and_b32 v127, 0xffff0000, v245
  v_and_or_b32 v137, v137, v114, v115
  v_lshlrev_b32_e64 v128, 16, v246
  v_and_b32 v129, 0xffff0000, v246
  v_and_or_b32 v138, v138, v114, v115
  v_lshlrev_b32_e64 v130, 16, v247
  v_and_b32 v131, 0xffff0000, v247
  v_and_or_b32 v139, v139, v114, v115
  s_waitcnt lgkmcnt(0)
L_s3b:
  s_mov_b32 s59, 0
  s_waitcnt vmcnt(4)
  s_nop 0
  s_add_u32 s57, s62, 6144
  buffer_load_dwordx4 v[40:43], v6, s[36:39], s57 offen offset:0 sc1
  buffer_load_dwordx4 v[44:47], v6, s[36:39], s57 offen offset:1024 sc1
  v_max3_u32 v2, v16, v17, v18
  v_max3_u32 v3, v19, v20, v21
  v_max3_u32 v2, v2, v22, v23
  v_max_u32 v2, v2, v3
  v_cmp_eq_u32 vcc, -1, v2
  s_cbranch_vccnz L_oretry0
L_ook0:
  s_setprio 3
  v_mfma_f32_16x16x32_bf16 v[116:119], v[140:143], v[16:19], v[116:119]
  ds_read_b64_tr_b16 v[140:141], v236 offset:24576
  ds_read_b64_tr_b16 v[142:143], v236 offset:26624
  v_mfma_f32_16x16x32_bf16 v[120:123], v[144:147], v[16:19], v[120:123]
  ds_read_b64_tr_b16 v[144:145], v237 offset:24576
  ds_read_b64_tr_b16 v[146:147], v237 offset:26624
  v_mfma_f32_16x16x32_bf16 v[124:127], v[148:151], v[16:19], v[124:127]
  ds_read_b64_tr_b16 v[148:149], v238 offset:24576
  ds_read_b64_tr_b16 v[150:151], v238 offset:26624
  v_mfma_f32_16x16x32_bf16 v[128:131], v[152:155], v[16:19], v[128:131]
  ds_read_b64_tr_b16 v[152:153], v239 offset:24576
  ds_read_b64_tr_b16 v[154:155], v239 offset:26624
  v_mfma_f32_16x16x32_bf16 v[116:119], v[156:159], v[20:23], v[116:119]
  ds_read_b64_tr_b16 v[156:157], v236 offset:28672
  ds_read_b64_tr_b16 v[158:159], v236 offset:30720
  v_mfma_f32_16x16x32_bf16 v[120:123], v[160:163], v[20:23], v[120:123]
  ds_read_b64_tr_b16 v[160:161], v237 offset:28672
  ds_read_b64_tr_b16 v[162:163], v237 offset:30720
  v_mfma_f32_16x16x32_bf16 v[124:127], v[164:167], v[20:23], v[124:127]
  ds_read_b64_tr_b16 v[164:165], v238 offset:28672
  ds_read_b64_tr_b16 v[166:167], v238 offset:30720
  v_mfma_f32_16x16x32_bf16 v[128:131], v[168:171], v[20:23], v[128:131]
  ds_read_b64_tr_b16 v[168:169], v239 offset:28672
  ds_read_b64_tr_b16 v[170:171], v239 offset:30720
  s_waitcnt vmcnt(4)
  s_nop 0
  s_add_u32 s57, s62, 8192
  buffer_load_dwordx4 v[16:19], v6, s[36:39], s57 offen offset:0 sc1
  buffer_load_dwordx4 v[20:23], v6, s[36:39], s57 offen offset:1024 sc1
  v_max3_u32 v2, v24, v25, v26
  v_max3_u32 v3, v27, v28, v29
  v_max3_u32 v2, v2, v30, v31
  v_max_u32 v2, v2, v3
  v_cmp_eq_u32_e64 vcc, -1, v2
  s_cbranch_vccnz L_oretry1
L_ook1:
  v_mfma_f32_16x16x32_bf16 v[116:119], v[172:175], v[24:27], v[116:119]
  ds_read_b64_tr_b16 v[172:173], v236 offset:32768
  ds_read_b64_tr_b16 v[174:175], v236 offset:34816
  v_mfma_f32_16x16x32_bf16 v[120:123], v[176:179], v[24:27], v[120:123]
  ds_read_b64_tr_b16 v[176:177], v237 offset:32768
  ds_read_b64_tr_b16 v[178:179], v237 offset:34816
  v_mfma_f32_16x16x32_bf16 v[124:127], v[180:183], v[24:27], v[124:127]
  ds_read_b64_tr_b16 v[180:181], v238 offset:32768
  ds_read_b64_tr_b16 v[182:183], v238 offset:34816
  v_mfma_f32_16x16x32_bf16 v[128:131], v[184:187], v[24:27], v[128:131]
  ds_read_b64_tr_b16 v[184:185], v239 offset:32768
  ds_read_b64_tr_b16 v[186:187], v239 offset:34816
  v_mfma_f32_16x16x32_bf16 v[116:119], v[188:191], v[28:31], v[116:119]
  ds_read_b64_tr_b16 v[188:189], v236 offset:36864
  ds_read_b64_tr_b16 v[190:191], v236 offset:38912
  v_mfma_f32_16x16x32_bf16 v[120:123], v[192:195], v[28:31], v[120:123]
  ds_read_b64_tr_b16 v[192:193], v237 offset:36864
  ds_read_b64_tr_b16 v[194:195], v237 offset:38912
  v_mfma_f32_16x16x32_bf16 v[124:127], v[196:199], v[28:31], v[124:127]
  ds_read_b64_tr_b16 v[196:197], v238 offset:36864
  ds_read_b64_tr_b16 v[198:199], v238 offset:38912
  v_mfma_f32_16x16x32_bf16 v[128:131], v[200:203], v[28:31], v[128:131]
  ds_read_b64_tr_b16 v[200:201], v239 offset:36864
  ds_read_b64_tr_b16 v[202:203], v239 offset:38912
  s_waitcnt vmcnt(4)
  s_nop 0
  s_add_u32 s57, s62, 10240
  buffer_load_dwordx4 v[24:27], v6, s[36:39], s57 offen offset:0 sc1
  buffer_load_dwordx4 v[28:31], v6, s[36:39], s57 offen offset:1024 sc1
  v_max3_u32 v2, v32, v33, v34
  v_max3_u32 v3, v35, v36, v37
  v_max3_u32 v2, v2, v38, v39
  v_max_u32 v2, v2, v3
  v_cmp_eq_u32 vcc, -1, v2
  s_cbranch_vccnz L_oretry2
L_ook2:
  s_setprio 2
  v_mfma_f32_16x16x32_bf16 v[116:119], v[204:207], v[32:35], v[116:119]
  ds_read_b64_tr_b16 v[204:205], v236 offset:40960
  ds_read_b64_tr_b16 v[206:207], v236 offset:43008
  v_mfma_f32_16x16x32_bf16 v[120:123], v[208:211], v[32:35], v[120:123]
  ds_read_b64_tr_b16 v[208:209], v237 offset:40960
  ds_read_b64_tr_b16 v[210:211], v237 offset:43008
  v_mfma_f32_16x16x32_bf16 v[124:127], v[212:215], v[32:35], v[124:127]
  ds_read_b64_tr_b16 v[212:213], v238 offset:40960
  ds_read_b64_tr_b16 v[214:215], v238 offset:43008
  v_mfma_f32_16x16x32_bf16 v[128:131], v[216:219], v[32:35], v[128:131]
  ds_read_b64_tr_b16 v[216:217], v239 offset:40960
  ds_read_b64_tr_b16 v[218:219], v239 offset:43008
  v_mfma_f32_16x16x32_bf16 v[116:119], v[220:223], v[36:39], v[116:119]
  ds_read_b64_tr_b16 v[220:221], v236 offset:45056
  ds_read_b64_tr_b16 v[222:223], v236 offset:47104
  v_mfma_f32_16x16x32_bf16 v[120:123], v[224:227], v[36:39], v[120:123]
  ds_read_b64_tr_b16 v[224:225], v237 offset:45056
  ds_read_b64_tr_b16 v[226:227], v237 offset:47104
  v_mfma_f32_16x16x32_bf16 v[124:127], v[228:231], v[36:39], v[124:127]
  ds_read_b64_tr_b16 v[228:229], v238 offset:45056
  ds_read_b64_tr_b16 v[230:231], v238 offset:47104
  v_mfma_f32_16x16x32_bf16 v[128:131], v[232:235], v[36:39], v[128:131]
  ds_read_b64_tr_b16 v[232:233], v239 offset:45056
  ds_read_b64_tr_b16 v[234:235], v239 offset:47104
  s_waitcnt vmcnt(4)
  s_nop 0
  s_add_u32 s57, s62, 12288
  buffer_load_dwordx4 v[32:35], v6, s[36:39], s57 offen offset:0 sc1
  buffer_load_dwordx4 v[36:39], v6, s[36:39], s57 offen offset:1024 sc1
  v_max3_u32 v2, v40, v41, v42
  v_max3_u32 v3, v43, v44, v45
  v_max3_u32 v2, v2, v46, v47
  v_max_u32 v2, v2, v3
  v_cmp_eq_u32 vcc, -1, v2
  s_cbranch_vccnz L_oretry3
L_ook3:
  s_waitcnt lgkmcnt(15)
  v_mfma_f32_16x16x32_bf16 v[116:119], v[140:143], v[40:43], v[116:119]
  ds_read_b64_tr_b16 v[140:141], v236 offset:49152
  ds_read_b64_tr_b16 v[142:143], v236 offset:51200
  v_mfma_f32_16x16x32_bf16 v[120:123], v[144:147], v[40:43], v[120:123]
  ds_read_b64_tr_b16 v[144:145], v237 offset:49152
  ds_read_b64_tr_b16 v[146:147], v237 offset:51200
  v_mfma_f32_16x16x32_bf16 v[124:127], v[148:151], v[40:43], v[124:127]
  ds_read_b64_tr_b16 v[148:149], v238 offset:49152
  ds_read_b64_tr_b16 v[150:151], v238 offset:51200
  v_mfma_f32_16x16x32_bf16 v[128:131], v[152:155], v[40:43], v[128:131]
  ds_read_b64_tr_b16 v[152:153], v239 offset:49152
  ds_read_b64_tr_b16 v[154:155], v239 offset:51200
  s_waitcnt lgkmcnt(15)
  s_nop 0
  v_mfma_f32_16x16x32_bf16 v[116:119], v[156:159], v[44:47], v[116:119]
  ds_read_b64_tr_b16 v[156:157], v236 offset:53248
  ds_read_b64_tr_b16 v[158:159], v236 offset:55296
  v_mfma_f32_16x16x32_bf16 v[120:123], v[160:163], v[44:47], v[120:123]
  ds_read_b64_tr_b16 v[160:161], v237 offset:53248
  ds_read_b64_tr_b16 v[162:163], v237 offset:55296
  v_mfma_f32_16x16x32_bf16 v[124:127], v[164:167], v[44:47], v[124:127]
  ds_read_b64_tr_b16 v[164:165], v238 offset:53248
  ds_read_b64_tr_b16 v[166:167], v238 offset:55296
  v_mfma_f32_16x16x32_bf16 v[128:131], v[168:171], v[44:47], v[128:131]
  ds_read_b64_tr_b16 v[168:169], v239 offset:53248
  ds_read_b64_tr_b16 v[170:171], v239 offset:55296
  s_waitcnt vmcnt(4)
  s_nop 0
  s_add_u32 s57, s62, 14336
  buffer_load_dwordx4 v[40:43], v6, s[36:39], s57 offen offset:0 sc1
  buffer_load_dwordx4 v[44:47], v6, s[36:39], s57 offen offset:1024 sc1
  v_max3_u32 v2, v16, v17, v18
  v_max3_u32 v3, v19, v20, v21
  v_max3_u32 v2, v2, v22, v23
  v_max_u32 v2, v2, v3
  v_cmp_eq_u32_e64 vcc, -1, v2
  s_cbranch_vccnz L_oretry4
L_ook4:
  s_setprio 1
  s_waitcnt lgkmcnt(15)
  v_mfma_f32_16x16x32_bf16 v[116:119], v[172:175], v[16:19], v[116:119]
  ds_read_b64_tr_b16 v[172:173], v236 offset:57344
  ds_read_b64_tr_b16 v[174:175], v236 offset:59392
  v_mfma_f32_16x16x32_bf16 v[120:123], v[176:179], v[16:19], v[120:123]
  ds_read_b64_tr_b16 v[176:177], v237 offset:57344
  ds_read_b64_tr_b16 v[178:179], v237 offset:59392
  v_mfma_f32_16x16x32_bf16 v[124:127], v[180:183], v[16:19], v[124:127]
  ds_read_b64_tr_b16 v[180:181], v238 offset:57344
  ds_read_b64_tr_b16 v[182:183], v238 offset:59392
  v_mfma_f32_16x16x32_bf16 v[128:131], v[184:187], v[16:19], v[128:131]
  ds_read_b64_tr_b16 v[184:185], v239 offset:57344
  ds_read_b64_tr_b16 v[186:187], v239 offset:59392
  s_waitcnt lgkmcnt(15)
  s_nop 0
  v_mfma_f32_16x16x32_bf16 v[116:119], v[188:191], v[20:23], v[116:119]
  ds_read_b64_tr_b16 v[188:189], v236 offset:61440
  ds_read_b64_tr_b16 v[190:191], v236 offset:63488
  v_mfma_f32_16x16x32_bf16 v[120:123], v[192:195], v[20:23], v[120:123]
  ds_read_b64_tr_b16 v[192:193], v237 offset:61440
  ds_read_b64_tr_b16 v[194:195], v237 offset:63488
  v_mfma_f32_16x16x32_bf16 v[124:127], v[196:199], v[20:23], v[124:127]
  ds_read_b64_tr_b16 v[196:197], v238 offset:61440
  ds_read_b64_tr_b16 v[198:199], v238 offset:63488
  v_mfma_f32_16x16x32_bf16 v[128:131], v[200:203], v[20:23], v[128:131]
  ds_read_b64_tr_b16 v[200:201], v239 offset:61440
  ds_read_b64_tr_b16 v[202:203], v239 offset:63488
  s_waitcnt vmcnt(4)
  s_nop 0
  s_add_u32 s57, s62, 16384
  buffer_load_dwordx4 v[16:19], v6, s[36:39], s57 offen offset:0 sc1
  buffer_load_dwordx4 v[20:23], v6, s[36:39], s57 offen offset:1024 sc1
  v_max3_u32 v2, v24, v25, v26
  v_max3_u32 v3, v27, v28, v29
  v_max3_u32 v2, v2, v30, v31
  v_max_u32 v2, v2, v3
  v_cmp_eq_u32 vcc, -1, v2
  s_cbranch_vccnz L_oretry5
L_ook5:
  s_waitcnt lgkmcnt(15)
  v_add_u32 v236, 0x10000, v236
  v_add_u32 v237, 0x10000, v237
  v_add_u32 v238, 0x10000, v238
  v_add_u32 v239, 0x10000, v239
  v_mfma_f32_16x16x32_bf16 v[116:119], v[204:207], v[24:27], v[116:119]
  ds_read_b64_tr_b16 v[204:205], v236 offset:0
  ds_read_b64_tr_b16 v[206:207], v236 offset:2048
  v_mfma_f32_16x16x32_bf16 v[120:123], v[208:211], v[24:27], v[120:123]
  ds_read_b64_tr_b16 v[208:209], v237 offset:0
  ds_read_b64_tr_b16 v[210:211], v237 offset:2048
  v_mfma_f32_16x16x32_bf16 v[124:127], v[212:215], v[24:27], v[124:127]
  ds_read_b64_tr_b16 v[212:213], v238 offset:0
  ds_read_b64_tr_b16 v[214:215], v238 offset:2048
  v_mfma_f32_16x16x32_bf16 v[128:131], v[216:219], v[24:27], v[128:131]
  ds_read_b64_tr_b16 v[216:217], v239 offset:0
  ds_read_b64_tr_b16 v[218:219], v239 offset:2048
  s_waitcnt lgkmcnt(15)
  s_nop 0
  v_mfma_f32_16x16x32_bf16 v[116:119], v[220:223], v[28:31], v[116:119]
  ds_read_b64_tr_b16 v[220:221], v236 offset:4096
  ds_read_b64_tr_b16 v[222:223], v236 offset:6144
  v_mfma_f32_16x16x32_bf16 v[120:123], v[224:227], v[28:31], v[120:123]
  ds_read_b64_tr_b16 v[224:225], v237 offset:4096
  ds_read_b64_tr_b16 v[226:227], v237 offset:6144
  v_mfma_f32_16x16x32_bf16 v[124:127], v[228:231], v[28:31], v[124:127]
  ds_read_b64_tr_b16 v[228:229], v238 offset:4096
  ds_read_b64_tr_b16 v[230:231], v238 offset:6144
  v_mfma_f32_16x16x32_bf16 v[128:131], v[232:235], v[28:31], v[128:131]
  ds_read_b64_tr_b16 v[232:233], v239 offset:4096
  ds_read_b64_tr_b16 v[234:235], v239 offset:6144
  s_waitcnt vmcnt(4)
  v_cmp_ne_u32 s[54:55], s53, v15
  s_nop 0
  s_cmp_eq_u64 s[54:55], 0
  s_cselect_b32 s53, 1, 0
  s_cmp_eq_u32 s53, 0
  s_cbranch_scc1 L_npt
  v_min_u32 v8, 17, v1
  v_lshlrev_b32 v8, 7, v8
  buffer_load_dword v15, v8, s[36:39], s51 offen
L_npt:
  v_max3_u32 v2, v32, v33, v34
  v_max3_u32 v3, v35, v36, v37
  v_max3_u32 v2, v2, v38, v39
  v_max_u32 v2, v2, v3
  v_cmp_eq_u32_e64 vcc, -1, v2
  s_cbranch_vccnz L_oretry6
L_ook6:
  s_setprio 0
  s_waitcnt lgkmcnt(15)
  v_mfma_f32_16x16x32_bf16 v[116:119], v[140:143], v[32:35], v[116:119]
  v_mfma_f32_16x16x32_bf16 v[120:123], v[144:147], v[32:35], v[120:123]
  v_mfma_f32_16x16x32_bf16 v[124:127], v[148:151], v[32:35], v[124:127]
  v_mfma_f32_16x16x32_bf16 v[128:131], v[152:155], v[32:35], v[128:131]
  s_waitcnt lgkmcnt(15)
  s_nop 0
  v_mfma_f32_16x16x32_bf16 v[116:119], v[156:159], v[36:39], v[116:119]
  v_mfma_f32_16x16x32_bf16 v[120:123], v[160:163], v[36:39], v[120:123]
  v_mfma_f32_16x16x32_bf16 v[124:127], v[164:167], v[36:39], v[124:127]
  v_mfma_f32_16x16x32_bf16 v[128:131], v[168:171], v[36:39], v[128:131]
  s_waitcnt vmcnt(2)
  s_nop 0
  v_max3_u32 v2, v40, v41, v42
  v_max3_u32 v3, v43, v44, v45
  v_max3_u32 v2, v2, v46, v47
  v_max_u32 v2, v2, v3
  v_cmp_eq_u32 vcc, -1, v2
  s_cbranch_vccnz L_oretry7
L_ook7:
  s_waitcnt lgkmcnt(15)
  v_mfma_f32_16x16x32_bf16 v[116:119], v[172:175], v[40:43], v[116:119]
  v_mfma_f32_16x16x32_bf16 v[120:123], v[176:179], v[40:43], v[120:123]
  v_mfma_f32_16x16x32_bf16 v[124:127], v[180:183], v[40:43], v[124:127]
  v_mfma_f32_16x16x32_bf16 v[128:131], v[184:187], v[40:43], v[128:131]
  s_waitcnt lgkmcnt(15)
  s_nop 0
  v_mfma_f32_16x16x32_bf16 v[116:119], v[188:191], v[44:47], v[116:119]
  v_mfma_f32_16x16x32_bf16 v[120:123], v[192:195], v[44:47], v[120:123]
  v_mfma_f32_16x16x32_bf16 v[124:127], v[196:199], v[44:47], v[124:127]
  v_mfma_f32_16x16x32_bf16 v[128:131], v[200:203], v[44:47], v[128:131]
  s_waitcnt vmcnt(0)
  s_nop 0
  v_max3_u32 v2, v16, v17, v18
  v_max3_u32 v3, v19, v20, v21
  v_max3_u32 v2, v2, v22, v23
  v_max_u32 v2, v2, v3
  v_cmp_eq_u32 vcc, -1, v2
  s_cbranch_vccnz L_oretry8
L_ook8:
  s_waitcnt lgkmcnt(8)
  v_mfma_f32_16x16x32_bf16 v[116:119], v[204:207], v[16:19], v[116:119]
  v_mfma_f32_16x16x32_bf16 v[120:123], v[208:211], v[16:19], v[120:123]
  v_mfma_f32_16x16x32_bf16 v[124:127], v[212:215], v[16:19], v[124:127]
  v_mfma_f32_16x16x32_bf16 v[128:131], v[216:219], v[16:19], v[128:131]
  s_waitcnt lgkmcnt(0)
  s_nop 0
  v_mfma_f32_16x16x32_bf16 v[116:119], v[220:223], v[20:23], v[116:119]
  v_mfma_f32_16x16x32_bf16 v[120:123], v[224:227], v[20:23], v[120:123]
  v_mfma_f32_16x16x32_bf16 v[124:127], v[228:231], v[20:23], v[124:127]
  v_mfma_f32_16x16x32_bf16 v[128:131], v[232:235], v[20:23], v[128:131]
  s_nop 4
  s_nop 0
  v_cvt_pk_bf16_f32 v64, v116, v117
  v_cvt_pk_bf16_f32 v65, v118, v119
  v_cvt_pk_bf16_f32 v66, v120, v121
  v_cvt_pk_bf16_f32 v67, v122, v123
  v_cvt_pk_bf16_f32 v68, v124, v125
  v_cvt_pk_bf16_f32 v69, v126, v127
  v_cvt_pk_bf16_f32 v70, v128, v129
  v_cvt_pk_bf16_f32 v71, v130, v131
  v_mfma_f32_16x16x32_bf16 v[20:23], v[64:67], v[64:67], 0
  v_mfma_f32_16x16x32_bf16 v[16:19], v[132:135], v[64:67], 0
  v_mfma_f32_16x16x32_bf16 v[20:23], v[68:71], v[68:71], v[20:23]
  v_mfma_f32_16x16x32_bf16 v[16:19], v[136:139], v[68:71], v[16:19]
  s_nop 6
  s_nop 0
  v_cndmask_b32_e64 v20, v20, v21, s[46:47]
  v_cndmask_b32_e64 v22, v22, v23, s[42:43]
  v_cndmask_b32_e64 v17, v20, v22, s[48:49]
  s_mov_b64 exec, s[44:45]
  s_cmp_eq_u32 s53, 0
  s_cbranch_scc1 L_ss
  buffer_store_dwordx3 v[16:18], v249, s[36:39], s52 offen
L_sb:
  s_mov_b64 exec, -1
  v_lshlrev_b32_e64 v72, 16, v64
  v_and_b32 v73, 0xffff0000, v64
  v_lshlrev_b32_e64 v74, 16, v65
  v_and_b32 v75, 0xffff0000, v65
  v_lshlrev_b32_e64 v76, 16, v66
  v_and_b32 v77, 0xffff0000, v66
  v_lshlrev_b32_e64 v78, 16, v67
  v_and_b32 v79, 0xffff0000, v67
  v_lshlrev_b32_e64 v80, 16, v68
  v_and_b32 v81, 0xffff0000, v68
  v_lshlrev_b32_e64 v82, 16, v69
  v_and_b32 v83, 0xffff0000, v69
  v_lshlrev_b32_e64 v84, 16, v70
  v_and_b32 v85, 0xffff0000, v70
  v_lshlrev_b32_e64 v86, 16, v71
  v_and_b32 v87, 0xffff0000, v71
  ds_write_b64 v250, v[64:65] offset:2304
  ds_write_b64 v250, v[66:67] offset:2336
  ds_write_b64 v250, v[68:69] offset:2368
  ds_write_b64 v250, v[70:71] offset:2400
  s_mov_b32 s59, 0
L_c1:
  s_nop 0
  buffer_load_dwordx3 v[20:22], v6, s[36:39], s51 offen sc1
  buffer_load_dwordx3 v[24:26], v6, s[36:39], s51 offen offset:1024 sc1
  buffer_load_dwordx3 v[28:30], v249, s[36:39], s51 offen offset:2048 sc1
  s_waitcnt vmcnt(0)
  s_nop 0
  v_max3_u32 v2, v20, v21, v22
  v_max3_u32 v3, v24, v25, v26
  v_max3_u32 v4, v28, v29, v30
  v_max3_u32 v2, v2, v3, v4
  v_cmp_eq_u32_e64 vcc, -1, v2
  s_cbranch_vccz L_c1ok
  s_add_u32 s59, s59, 1
  s_cmp_lt_u32 s59, 131072
  s_cbranch_scc1 L_c1
L_c1ok:
  v_add_f32 v16, v20, v24
  v_add_f32 v20, v20, v24
  v_add_f32 v17, v21, v25
  v_add_f32 v21, v21, v25
  v_add_f32 v18, v22, v26
  v_add_f32 v22, v22, v26
  v_permlane16_swap_b32 v16, v20
  v_permlane16_swap_b32 v17, v21
  v_permlane16_swap_b32 v18, v22
  v_add_f32 v24, v16, v20
  v_add_f32 v16, v16, v20
  v_add_f32 v25, v17, v21
  v_add_f32 v17, v17, v21
  v_add_f32 v26, v18, v22
  v_add_f32 v18, v18, v22
  v_permlane32_swap_b32 v16, v24
  v_permlane32_swap_b32 v17, v25
  v_permlane32_swap_b32 v18, v26
  v_add_f32 v16, v16, v24
  v_add_f32 v17, v17, v25
  v_add_f32 v18, v18, v26
  v_add_f32 v16, v16, v28
  v_add_f32 v17, v17, v29
  v_add_f32_e64 v18, v18, v30
  v_mul_f32 v16, 0x3ae38e39, v16
  v_mul_f32 v17, 0x3ae38e39, v17
  v_fma_f32 v17, -v16, v16, v17
  v_max_f32_e64 v17, 0, v17
  v_cvt_pk_bf16_f32 v20, v16, v17
  v_lshlrev_b32_e64 v16, 16, v20
  v_and_b32 v17, 0xffff0000, v20
  v_add_f32 v17, 0x3727c5ac, v17
  v_cvt_pk_bf16_f32 v17, v17, v17
  v_and_b32 v17, 0xffff0000, v17
  v_sqrt_f32_e64 v17, v17
  v_fma_f32 v18, -v16, v255, v18
  v_cvt_pk_bf16_f32 v17, v17, v17
  v_and_b32 v17, 0xffff0000, v17
  v_rcp_f32 v56, v17
  s_nop 0
  v_mul_f32_e64 v18, v18, v56
  v_cvt_pk_bf16_f32 v18, v18, v18
  v_ashrrev_i32_e64 v20, 31, v18
  v_or_b32 v20, 0x80000000, v20
  v_xor_b32_e64 v18, v18, v20
  s_mov_b32 s57, 0xffff0000
  v_and_or_b32 v18, v18, s57, v254
  s_nop 1
  v_max_u32_dpp v20, v18, v18 quad_perm:[1,0,3,2] row_mask:0xf bank_mask:0xf
  s_nop 1
  v_max_u32_dpp v20, v20, v20 quad_perm:[2,3,0,1] row_mask:0xf bank_mask:0xf
  s_nop 1
  v_max_u32_dpp v20, v20, v20 row_half_mirror row_mask:0xf bank_mask:0xf
  s_nop 1
  v_max_u32_dpp v20, v20, v20 row_mirror row_mask:0xf bank_mask:0xf
  v_cmp_eq_u32 s[40:41], v18, v20
  s_nop 1
  v_cndmask_b32_e64 v22, v18, 0, s[40:41]
  s_nop 1
  v_max_u32_dpp v21, v22, v22 quad_perm:[1,0,3,2] row_mask:0xf bank_mask:0xf
  s_nop 1
  v_max_u32_dpp v21, v21, v21 quad_perm:[2,3,0,1] row_mask:0xf bank_mask:0xf
  s_nop 1
  v_max_u32_dpp v21, v21, v21 row_half_mirror row_mask:0xf bank_mask:0xf
  s_nop 1
  v_max_u32_dpp v21, v21, v21 row_mirror row_mask:0xf bank_mask:0xf
  ds_write_b64 v11, v[20:21]
  s_lshr_b32 s58, s60, 3
  s_lshl_b32 s57, s58, 7
  s_add_u32 s57, s57, 3047424
  s_lshl_b32 s56, s63, 11
  s_add_u32 s57, s57, s56
  s_mov_b32 s56, s3
  v_mov_b32_e64 v23, 0
  s_waitcnt lgkmcnt(0)
  s_barrier
  ds_read_b32 v18, v5
  s_waitcnt lgkmcnt(0)
  v_max_u32_dpp v20, v18, v18 quad_perm:[1,0,3,2] row_mask:0xf bank_mask:0xf
  s_nop 1
  v_max_u32_dpp v20, v20, v20 quad_perm:[2,3,0,1] row_mask:0xf bank_mask:0xf
  s_nop 1
  v_max_u32_dpp v20, v20, v20 row_half_mirror row_mask:0xf bank_mask:0xf
  s_nop 1
  v_max_u32_dpp v20, v20, v20 row_mirror row_mask:0xf bank_mask:0xf
  v_cmp_eq_u32 s[40:41], v18, v20
  s_nop 1
  v_cndmask_b32_e64 v22, v18, 0, s[40:41]
  s_nop 1
  v_max_u32_dpp v21, v22, v22 quad_perm:[1,0,3,2] row_mask:0xf bank_mask:0xf
  s_nop 1
  v_max_u32_dpp v21, v21, v21 quad_perm:[2,3,0,1] row_mask:0xf bank_mask:0xf
  s_nop 1
  v_max_u32_dpp v21, v21, v21 row_half_mirror row_mask:0xf bank_mask:0xf
  s_nop 1
  v_max_u32_dpp v21, v21, v21 row_mirror row_mask:0xf bank_mask:0xf
  s_cmp_lg_u32 s56, 0
  s_cbranch_scc1 L_nokey
  s_mov_b64 exec, 1
  buffer_store_dwordx2 v[20:21], v23, s[36:39], s57 offen sc1
  s_mov_b64 exec, -1
L_nokey:
  s_mov_b64 s[40:41], 0xff
  v_cndmask_b32_e64 v20, v21, v20, s[40:41]
  v_not_b32 v20, v20
  v_bfe_u32 v22, v20, 4, 3
  v_cmp_eq_u32 s[46:47], s3, v22
  s_nop 0
  s_and_b64 s[46:47], s[46:47], 0xffff
  s_cbranch_scc0 L_noown
  s_setprio 3
L_noown:
  s_nop 0
  v_pk_add_f32 v[40:41], v[72:73], v[16:17] op_sel_hi:[1,0] neg_lo:[0,1] neg_hi:[0,1]
  v_pk_add_f32 v[42:43], v[74:75], v[16:17] op_sel_hi:[1,0] neg_lo:[0,1] neg_hi:[0,1]
  v_pk_add_f32 v[44:45], v[76:77], v[16:17] op_sel_hi:[1,0] neg_lo:[0,1] neg_hi:[0,1]
  v_pk_add_f32 v[46:47], v[78:79], v[16:17] op_sel_hi:[1,0] neg_lo:[0,1] neg_hi:[0,1]
  v_pk_add_f32 v[48:49], v[80:81], v[16:17] op_sel_hi:[1,0] neg_lo:[0,1] neg_hi:[0,1]
  v_pk_add_f32 v[50:51], v[82:83], v[16:17] op_sel_hi:[1,0] neg_lo:[0,1] neg_hi:[0,1]
  v_pk_add_f32 v[52:53], v[84:85], v[16:17] op_sel_hi:[1,0] neg_lo:[0,1] neg_hi:[0,1]
  v_pk_add_f32 v[54:55], v[86:87], v[16:17] op_sel_hi:[1,0] neg_lo:[0,1] neg_hi:[0,1]
  v_cvt_pk_bf16_f32 v32, v40, v41
  v_cvt_pk_bf16_f32 v33, v42, v43
  v_cvt_pk_bf16_f32 v34, v44, v45
  v_cvt_pk_bf16_f32 v35, v46, v47
  v_cvt_pk_bf16_f32 v36, v48, v49
  v_cvt_pk_bf16_f32 v37, v50, v51
  v_cvt_pk_bf16_f32 v38, v52, v53
  v_cvt_pk_bf16_f32 v39, v54, v55
  v_lshlrev_b32_e64 v40, 16, v32
  v_and_b32 v41, 0xffff0000, v32
  v_lshlrev_b32_e64 v42, 16, v33
  v_and_b32 v43, 0xffff0000, v33
  v_lshlrev_b32_e64 v44, 16, v34
  v_and_b32 v45, 0xffff0000, v34
  v_lshlrev_b32_e64 v46, 16, v35
  v_and_b32 v47, 0xffff0000, v35
  v_lshlrev_b32_e64 v48, 16, v36
  v_and_b32 v49, 0xffff0000, v36
  v_lshlrev_b32_e64 v50, 16, v37
  v_and_b32 v51, 0xffff0000, v37
  v_lshlrev_b32_e64 v52, 16, v38
  v_and_b32 v53, 0xffff0000, v38
  v_lshlrev_b32_e64 v54, 16, v39
  v_and_b32 v55, 0xffff0000, v39
  v_pk_mul_f32 v[40:41], v[40:41], v[56:57] op_sel_hi:[1,0]
  v_pk_mul_f32 v[42:43], v[42:43], v[56:57] op_sel_hi:[1,0]
  v_pk_mul_f32 v[44:45], v[44:45], v[56:57] op_sel_hi:[1,0]
  v_pk_mul_f32 v[46:47], v[46:47], v[56:57] op_sel_hi:[1,0]
  v_pk_mul_f32 v[48:49], v[48:49], v[56:57] op_sel_hi:[1,0]
  v_pk_mul_f32 v[50:51], v[50:51], v[56:57] op_sel_hi:[1,0]
  v_pk_mul_f32 v[52:53], v[52:53], v[56:57] op_sel_hi:[1,0]
  v_pk_mul_f32 v[54:55], v[54:55], v[56:57] op_sel_hi:[1,0]
  v_cvt_pk_bf16_f32 v32, v40, v41
  v_cvt_pk_bf16_f32 v33, v42, v43
  v_cvt_pk_bf16_f32 v34, v44, v45
  v_cvt_pk_bf16_f32 v35, v46, v47
  v_cvt_pk_bf16_f32 v36, v48, v49
  v_cvt_pk_bf16_f32 v37, v50, v51
  v_cvt_pk_bf16_f32 v38, v52, v53
  v_cvt_pk_bf16_f32 v39, v54, v55
  ds_write_b64 v250, v[32:33] offset:0
  ds_write_b64 v250, v[34:35] offset:32
  ds_write_b64 v250, v[36:37] offset:64
  ds_write_b64 v250, v[38:39] offset:96
  v_and_b32_e64 v20, 15, v20
  v_mul_u32_u24 v20, 144, v20
  v_lshl_add_u32 v20, v253, 4, v20
  v_add_u32_e64 v20, s50, v20
  v_bfe_u32 v21, v1, 3, 1
  v_mul_u32_u24 v21, 2304, v21
  v_lshl_add_u32 v21, v253, 4, v21
  s_mul_i32 s62, s58, 4608
  s_lshl_b32 s57, s63, 7
  s_add_u32 s62, s62, s57
  s_add_u32 s62, s62, 3067904
  s_cmp_eq_u64 s[46:47], 0
  s_cbranch_scc1 L_nocand
  s_waitcnt lgkmcnt(0)
  ds_read_b128 v[24:27], v20
  ds_read_b128 v[28:31], v20 offset:2304
  s_waitcnt lgkmcnt(0)
  s_mov_b64 exec, s[46:47]
  buffer_store_dwordx4 v[24:27], v21, s[36:39], s62 offen sc1
  s_mov_b64 exec, -1
L_nocand:
  v_lshlrev_b32_e64 v40, 16, v32
  v_and_b32 v41, 0xffff0000, v32
  v_lshlrev_b32_e64 v42, 16, v33
  v_and_b32 v43, 0xffff0000, v33
  v_lshlrev_b32_e64 v44, 16, v34
  v_and_b32 v45, 0xffff0000, v34
  v_lshlrev_b32_e64 v46, 16, v35
  v_and_b32 v47, 0xffff0000, v35
  v_lshlrev_b32_e64 v48, 16, v36
  v_and_b32 v49, 0xffff0000, v36
  v_lshlrev_b32_e64 v50, 16, v37
  v_and_b32 v51, 0xffff0000, v37
  v_lshlrev_b32_e64 v52, 16, v38
  v_and_b32 v53, 0xffff0000, v38
  v_lshlrev_b32_e64 v54, 16, v39
  v_and_b32 v55, 0xffff0000, v39
  v_pk_add_f32 v[40:41], v[40:41], v[72:73]
  v_pk_add_f32 v[42:43], v[42:43], v[74:75]
  v_pk_add_f32 v[44:45], v[44:45], v[76:77]
  v_pk_add_f32 v[46:47], v[46:47], v[78:79]
  v_pk_add_f32 v[48:49], v[48:49], v[80:81]
  v_pk_add_f32 v[50:51], v[50:51], v[82:83]
  v_pk_add_f32 v[52:53], v[52:53], v[84:85]
  v_pk_add_f32 v[54:55], v[54:55], v[86:87]
  v_cvt_pk_bf16_f32 v32, v40, v41
  v_cvt_pk_bf16_f32 v33, v42, v43
  v_cvt_pk_bf16_f32 v34, v44, v45
  v_cvt_pk_bf16_f32 v35, v46, v47
  v_cvt_pk_bf16_f32 v36, v48, v49
  v_cvt_pk_bf16_f32 v37, v50, v51
  v_cvt_pk_bf16_f32 v38, v52, v53
  v_cvt_pk_bf16_f32 v39, v54, v55
  ds_write_b64 v250, v[32:33] offset:0
  ds_write_b64 v250, v[34:35] offset:32
  ds_write_b64 v250, v[36:37] offset:64
  ds_write_b64 v250, v[38:39] offset:96
  s_mov_b32 s68, s20
  s_mov_b32 s69, s21
  s_mov_b32 s70, 2359296
  s_mov_b32 s71, 0x20000
  s_waitcnt lgkmcnt(0)
  s_nop 0
  ds_read_b128 v[40:43], v251
  ds_read_b128 v[44:47], v251 offset:1152
  s_add_u32 s57, s61, 9216
  s_waitcnt lgkmcnt(0)
  s_barrier
  s_cmp_eq_u64 s[46:47], 0
  s_cbranch_scc0 L_own
  buffer_store_dwordx4 v[40:43], v252, s[68:71], s61 offen sc1
  buffer_store_dwordx4 v[44:47], v252, s[68:71], s57 offen sc1
  s_branch L_s3end
L_own:
  buffer_store_dwordx4 v[40:43], v252, s[68:71], s61 offen sc1
  buffer_store_dwordx4 v[44:47], v252, s[68:71], s57 offen sc1
  s_waitcnt vmcnt(0)
  s_mov_b64 exec, s[46:47]
  buffer_store_dwordx4 v[28:31], v21, s[36:39], s62 offen offset:1152 sc1
L_s3end:
  s_endpgm
L_ss:
  buffer_store_dwordx3 v[16:18], v249, s[36:39], s52 offen sc1
  s_waitcnt vmcnt(0)
  s_branch L_sb
L_oretry0:
  s_add_u32 s59, s59, 1
  s_cmp_ge_u32 s59, 131072
  s_cbranch_scc1 L_ook0
  s_add_u32 s57, s62, 0
  buffer_load_dwordx4 v[16:19], v6, s[36:39], s57 offen offset:0 sc1
  buffer_load_dwordx4 v[20:23], v6, s[36:39], s57 offen offset:1024 sc1
  s_waitcnt vmcnt(0)
  v_max3_u32 v2, v16, v17, v18
  v_max3_u32 v3, v19, v20, v21
  v_max3_u32 v2, v2, v22, v23
  v_max_u32 v2, v2, v3
  v_cmp_eq_u32_e64 vcc, -1, v2
  s_cbranch_vccnz L_oretry0
  s_branch L_ook0
L_oretry1:
  s_add_u32 s59, s59, 1
  s_cmp_ge_u32 s59, 131072
  s_cbranch_scc1 L_ook1
  s_nop 0
  s_add_u32 s57, s62, 2048
  buffer_load_dwordx4 v[24:27], v6, s[36:39], s57 offen offset:0 sc1
  buffer_load_dwordx4 v[28:31], v6, s[36:39], s57 offen offset:1024 sc1
  s_waitcnt vmcnt(0)
  s_nop 0
  v_max3_u32 v2, v24, v25, v26
  v_max3_u32 v3, v27, v28, v29
  v_max3_u32 v2, v2, v30, v31
  v_max_u32 v2, v2, v3
  v_cmp_eq_u32_e64 vcc, -1, v2
  s_cbranch_vccnz L_oretry1
  s_branch L_ook1
L_oretry2:
  s_add_u32 s59, s59, 1
  s_cmp_ge_u32 s59, 131072
  s_cbranch_scc1 L_ook2
  s_nop 0
  s_add_u32 s57, s62, 4096
  buffer_load_dwordx4 v[32:35], v6, s[36:39], s57 offen offset:0 sc1
  buffer_load_dwordx4 v[36:39], v6, s[36:39], s57 offen offset:1024 sc1
  s_waitcnt vmcnt(0)
  s_nop 0
  v_max3_u32 v2, v32, v33, v34
  v_max3_u32 v3, v35, v36, v37
  v_max3_u32 v2, v2, v38, v39
  v_max_u32 v2, v2, v3
  v_cmp_eq_u32_e64 vcc, -1, v2
  s_cbranch_vccnz L_oretry2
  s_branch L_ook2
L_oretry3:
  s_add_u32 s59, s59, 1
  s_cmp_ge_u32 s59, 131072
  s_cbranch_scc1 L_ook3
  s_nop 0
  s_add_u32 s57, s62, 6144
  buffer_load_dwordx4 v[40:43], v6, s[36:39], s57 offen offset:0 sc1
  buffer_load_dwordx4 v[44:47], v6, s[36:39], s57 offen offset:1024 sc1
  s_waitcnt vmcnt(0)
  s_nop 0
  v_max3_u32 v2, v40, v41, v42
  v_max3_u32 v3, v43, v44, v45
  v_max3_u32 v2, v2, v46, v47
  v_max_u32 v2, v2, v3
  v_cmp_eq_u32_e64 vcc, -1, v2
  s_cbranch_vccnz L_oretry3
  s_branch L_ook3
L_oretry4:
  s_add_u32 s59, s59, 1
  s_cmp_ge_u32 s59, 131072
  s_cbranch_scc1 L_ook4
  s_nop 0
  s_add_u32 s57, s62, 8192
  buffer_load_dwordx4 v[16:19], v6, s[36:39], s57 offen offset:0 sc1
  buffer_load_dwordx4 v[20:23], v6, s[36:39], s57 offen offset:1024 sc1
  s_waitcnt vmcnt(0)
  s_nop 0
  v_max3_u32 v2, v16, v17, v18
  v_max3_u32 v3, v19, v20, v21
  v_max3_u32 v2, v2, v22, v23
  v_max_u32 v2, v2, v3
  v_cmp_eq_u32_e64 vcc, -1, v2
  s_cbranch_vccnz L_oretry4
  s_branch L_ook4
L_oretry5:
  s_add_u32 s59, s59, 1
  s_cmp_ge_u32 s59, 131072
  s_cbranch_scc1 L_ook5
  s_nop 0
  s_add_u32 s57, s62, 10240
  buffer_load_dwordx4 v[24:27], v6, s[36:39], s57 offen offset:0 sc1
  buffer_load_dwordx4 v[28:31], v6, s[36:39], s57 offen offset:1024 sc1
  s_waitcnt vmcnt(0)
  s_nop 0
  v_max3_u32 v2, v24, v25, v26
  v_max3_u32 v3, v27, v28, v29
  v_max3_u32 v2, v2, v30, v31
  v_max_u32 v2, v2, v3
  v_cmp_eq_u32_e64 vcc, -1, v2
  s_cbranch_vccnz L_oretry5
  s_branch L_ook5
L_oretry6:
  s_add_u32 s59, s59, 1
  s_cmp_ge_u32 s59, 131072
  s_cbranch_scc1 L_ook6
  s_nop 0
  s_add_u32 s57, s62, 12288
  buffer_load_dwordx4 v[32:35], v6, s[36:39], s57 offen offset:0 sc1
  buffer_load_dwordx4 v[36:39], v6, s[36:39], s57 offen offset:1024 sc1
  s_waitcnt vmcnt(0)
  s_nop 0
  v_max3_u32 v2, v32, v33, v34
  v_max3_u32 v3, v35, v36, v37
  v_max3_u32 v2, v2, v38, v39
  v_max_u32 v2, v2, v3
  v_cmp_eq_u32_e64 vcc, -1, v2
  s_cbranch_vccnz L_oretry6
  s_branch L_ook6
L_oretry7:
  s_add_u32 s59, s59, 1
  s_cmp_ge_u32 s59, 131072
  s_cbranch_scc1 L_ook7
  s_nop 0
  s_add_u32 s57, s62, 14336
  buffer_load_dwordx4 v[40:43], v6, s[36:39], s57 offen offset:0 sc1
  buffer_load_dwordx4 v[44:47], v6, s[36:39], s57 offen offset:1024 sc1
  s_waitcnt vmcnt(0)
  s_nop 0
  v_max3_u32 v2, v40, v41, v42
  v_max3_u32 v3, v43, v44, v45
  v_max3_u32 v2, v2, v46, v47
  v_max_u32 v2, v2, v3
  v_cmp_eq_u32_e64 vcc, -1, v2
  s_cbranch_vccnz L_oretry7
  s_branch L_ook7
L_oretry8:
  s_add_u32 s59, s59, 1
  s_cmp_ge_u32 s59, 131072
  s_cbranch_scc1 L_ook8
  s_nop 0
  s_add_u32 s57, s62, 16384
  buffer_load_dwordx4 v[16:19], v6, s[36:39], s57 offen offset:0 sc1
  buffer_load_dwordx4 v[20:23], v6, s[36:39], s57 offen offset:1024 sc1
  s_waitcnt vmcnt(0)
  s_nop 0
  v_max3_u32 v2, v16, v17, v18
  v_max3_u32 v3, v19, v20, v21
  v_max3_u32 v2, v2, v22, v23
  v_max_u32 v2, v2, v3
  v_cmp_eq_u32_e64 vcc, -1, v2
  s_cbranch_vccnz L_oretry8
  s_branch L_ook8
L_B:
  s_barrier
  s_cmp_ge_u32 s27, 24
  s_cbranch_scc1 L_X
  buffer_load_dwordx4 v[32:35], v2, s[32:35], s56 offen
  buffer_load_dwordx4 v[36:39], v5, s[32:35], s56 offen
  s_add_u32 s56, s56, s57
  s_barrier
  s_mov_b32 s36, s24
  s_mov_b32 s37, s25
  s_mov_b32 s38, 268435456
  s_mov_b32 s39, 0x20000
  s_mov_b32 s64, s22
  s_mov_b32 s65, s23
  s_mov_b32 s66, 256
  s_mov_b32 s67, 0x20000
  v_mov_b32_e64 v113, 0
  buffer_load_dwordx4 v[40:43], v2, s[32:35], s56 offen
  buffer_load_dwordx4 v[44:47], v5, s[32:35], s56 offen
  s_add_u32 s56, s56, s57
  s_barrier
  s_waitcnt vmcnt(6)
  v_lshlrev_b32 v88, 16, v16
  v_and_b32 v89, 0xffff0000, v16
  v_lshlrev_b32_e64 v90, 16, v17
  v_and_b32 v91, 0xffff0000, v17
  v_lshlrev_b32_e64 v92, 16, v18
  v_and_b32 v93, 0xffff0000, v18
  v_lshlrev_b32_e64 v94, 16, v19
  v_and_b32 v95, 0xffff0000, v19
  v_lshlrev_b32_e64 v96, 16, v20
  v_and_b32 v97, 0xffff0000, v20
  v_lshlrev_b32_e64 v98, 16, v21
  v_and_b32 v99, 0xffff0000, v21
  v_lshlrev_b32_e64 v100, 16, v22
  v_and_b32 v101, 0xffff0000, v22
  v_lshlrev_b32_e64 v102, 16, v23
  v_and_b32 v103, 0xffff0000, v23
  buffer_load_dwordx4 v[48:51], v2, s[32:35], s56 offen
  buffer_load_dwordx4 v[52:55], v5, s[32:35], s56 offen
  s_add_u32 s56, s56, s57
  s_barrier
  s_waitcnt vmcnt(6)
  v_lshlrev_b32 v104, 16, v24
  v_and_b32 v105, 0xffff0000, v24
  v_lshlrev_b32_e64 v106, 16, v25
  v_and_b32 v107, 0xffff0000, v25
  v_lshlrev_b32_e64 v108, 16, v26
  v_and_b32 v109, 0xffff0000, v26
  v_lshlrev_b32_e64 v110, 16, v27
  v_and_b32 v111, 0xffff0000, v27
  v_pk_add_f32 v[88:89], v[88:89], v[104:105]
  v_pk_add_f32 v[90:91], v[90:91], v[106:107]
  v_pk_add_f32 v[92:93], v[92:93], v[108:109]
  v_pk_add_f32 v[94:95], v[94:95], v[110:111]
  v_lshlrev_b32_e64 v104, 16, v28
  v_and_b32 v105, 0xffff0000, v28
  v_lshlrev_b32_e64 v106, 16, v29
  v_and_b32 v107, 0xffff0000, v29
  v_lshlrev_b32_e64 v108, 16, v30
  v_and_b32 v109, 0xffff0000, v30
  v_lshlrev_b32_e64 v110, 16, v31
  v_and_b32 v111, 0xffff0000, v31
  v_pk_add_f32 v[96:97], v[96:97], v[104:105]
  v_pk_add_f32 v[98:99], v[98:99], v[106:107]
  v_pk_add_f32 v[100:101], v[100:101], v[108:109]
  v_pk_add_f32 v[102:103], v[102:103], v[110:111]
  buffer_load_dwordx4 v[56:59], v2, s[32:35], s56 offen
  buffer_load_dwordx4 v[60:63], v5, s[32:35], s56 offen
  s_add_u32 s56, s56, s57
  s_barrier
  s_waitcnt vmcnt(6)
  v_lshlrev_b32 v104, 16, v32
  v_and_b32 v105, 0xffff0000, v32
  v_lshlrev_b32_e64 v106, 16, v33
  v_and_b32 v107, 0xffff0000, v33
  v_lshlrev_b32_e64 v108, 16, v34
  v_and_b32 v109, 0xffff0000, v34
  v_lshlrev_b32_e64 v110, 16, v35
  v_and_b32 v111, 0xffff0000, v35
  v_pk_add_f32 v[88:89], v[88:89], v[104:105]
  v_pk_add_f32 v[90:91], v[90:91], v[106:107]
  v_pk_add_f32 v[92:93], v[92:93], v[108:109]
  v_pk_add_f32 v[94:95], v[94:95], v[110:111]
  v_lshlrev_b32_e64 v104, 16, v36
  v_and_b32 v105, 0xffff0000, v36
  v_lshlrev_b32_e64 v106, 16, v37
  v_and_b32 v107, 0xffff0000, v37
  v_lshlrev_b32_e64 v108, 16, v38
  v_and_b32 v109, 0xffff0000, v38
  v_lshlrev_b32_e64 v110, 16, v39
  v_and_b32 v111, 0xffff0000, v39
  v_pk_add_f32 v[96:97], v[96:97], v[104:105]
  v_pk_add_f32 v[98:99], v[98:99], v[106:107]
  v_pk_add_f32 v[100:101], v[100:101], v[108:109]
  v_pk_add_f32 v[102:103], v[102:103], v[110:111]
  buffer_load_dwordx4 v[64:67], v2, s[32:35], s56 offen
  buffer_load_dwordx4 v[68:71], v5, s[32:35], s56 offen
  s_add_u32 s56, s56, s57
  s_barrier
  s_waitcnt vmcnt(6)
  v_lshlrev_b32 v104, 16, v40
  v_and_b32 v105, 0xffff0000, v40
  v_lshlrev_b32_e64 v106, 16, v41
  v_and_b32 v107, 0xffff0000, v41
  v_lshlrev_b32_e64 v108, 16, v42
  v_and_b32 v109, 0xffff0000, v42
  v_lshlrev_b32_e64 v110, 16, v43
  v_and_b32 v111, 0xffff0000, v43
  v_pk_add_f32 v[88:89], v[88:89], v[104:105]
  v_pk_add_f32 v[90:91], v[90:91], v[106:107]
  v_pk_add_f32 v[92:93], v[92:93], v[108:109]
  v_pk_add_f32 v[94:95], v[94:95], v[110:111]
  v_lshlrev_b32_e64 v104, 16, v44
  v_and_b32 v105, 0xffff0000, v44
  v_lshlrev_b32_e64 v106, 16, v45
  v_and_b32 v107, 0xffff0000, v45
  v_lshlrev_b32_e64 v108, 16, v46
  v_and_b32 v109, 0xffff0000, v46
  v_lshlrev_b32_e64 v110, 16, v47
  v_and_b32 v111, 0xffff0000, v47
  v_pk_add_f32 v[96:97], v[96:97], v[104:105]
  v_pk_add_f32 v[98:99], v[98:99], v[106:107]
  v_pk_add_f32 v[100:101], v[100:101], v[108:109]
  v_pk_add_f32 v[102:103], v[102:103], v[110:111]
  buffer_load_dwordx4 v[72:75], v2, s[32:35], s56 offen
  buffer_load_dwordx4 v[76:79], v5, s[32:35], s56 offen
  s_add_u32 s56, s56, s57
  s_barrier
  s_waitcnt vmcnt(6)
  v_lshlrev_b32 v104, 16, v48
  v_and_b32 v105, 0xffff0000, v48
  v_lshlrev_b32_e64 v106, 16, v49
  v_and_b32 v107, 0xffff0000, v49
  v_lshlrev_b32_e64 v108, 16, v50
  v_and_b32 v109, 0xffff0000, v50
  v_lshlrev_b32_e64 v110, 16, v51
  v_and_b32 v111, 0xffff0000, v51
  v_pk_add_f32 v[88:89], v[88:89], v[104:105]
  v_pk_add_f32 v[90:91], v[90:91], v[106:107]
  v_pk_add_f32 v[92:93], v[92:93], v[108:109]
  v_pk_add_f32 v[94:95], v[94:95], v[110:111]
  v_lshlrev_b32_e64 v104, 16, v52
  v_and_b32 v105, 0xffff0000, v52
  v_lshlrev_b32_e64 v106, 16, v53
  v_and_b32 v107, 0xffff0000, v53
  v_lshlrev_b32_e64 v108, 16, v54
  v_and_b32 v109, 0xffff0000, v54
  v_lshlrev_b32_e64 v110, 16, v55
  v_and_b32 v111, 0xffff0000, v55
  v_pk_add_f32 v[96:97], v[96:97], v[104:105]
  v_pk_add_f32 v[98:99], v[98:99], v[106:107]
  v_pk_add_f32 v[100:101], v[100:101], v[108:109]
  v_pk_add_f32 v[102:103], v[102:103], v[110:111]
  buffer_load_dwordx4 v[80:83], v2, s[32:35], s56 offen
  buffer_load_dwordx4 v[84:87], v5, s[32:35], s56 offen
  buffer_load_dword v112, v113, s[64:67], 0 offen offset:128 sc1
  s_waitcnt vmcnt(7)
  v_lshlrev_b32 v104, 16, v56
  v_and_b32 v105, 0xffff0000, v56
  v_lshlrev_b32_e64 v106, 16, v57
  v_and_b32 v107, 0xffff0000, v57
  v_lshlrev_b32_e64 v108, 16, v58
  v_and_b32 v109, 0xffff0000, v58
  v_lshlrev_b32_e64 v110, 16, v59
  v_and_b32 v111, 0xffff0000, v59
  v_pk_add_f32 v[88:89], v[88:89], v[104:105]
  v_pk_add_f32 v[90:91], v[90:91], v[106:107]
  v_pk_add_f32 v[92:93], v[92:93], v[108:109]
  v_pk_add_f32 v[94:95], v[94:95], v[110:111]
  v_lshlrev_b32_e64 v104, 16, v60
  v_and_b32 v105, 0xffff0000, v60
  v_lshlrev_b32_e64 v106, 16, v61
  v_and_b32 v107, 0xffff0000, v61
  v_lshlrev_b32_e64 v108, 16, v62
  v_and_b32 v109, 0xffff0000, v62
  v_lshlrev_b32_e64 v110, 16, v63
  v_and_b32 v111, 0xffff0000, v63
  v_pk_add_f32 v[96:97], v[96:97], v[104:105]
  v_pk_add_f32 v[98:99], v[98:99], v[106:107]
  v_pk_add_f32 v[100:101], v[100:101], v[108:109]
  v_pk_add_f32 v[102:103], v[102:103], v[110:111]
  s_waitcnt vmcnt(5)
  v_lshlrev_b32 v104, 16, v64
  v_and_b32 v105, 0xffff0000, v64
  v_lshlrev_b32_e64 v106, 16, v65
  v_and_b32 v107, 0xffff0000, v65
  v_lshlrev_b32_e64 v108, 16, v66
  v_and_b32 v109, 0xffff0000, v66
  v_lshlrev_b32_e64 v110, 16, v67
  v_and_b32 v111, 0xffff0000, v67
  v_pk_add_f32 v[88:89], v[88:89], v[104:105]
  v_pk_add_f32 v[90:91], v[90:91], v[106:107]
  v_pk_add_f32 v[92:93], v[92:93], v[108:109]
  v_pk_add_f32 v[94:95], v[94:95], v[110:111]
  v_lshlrev_b32_e64 v104, 16, v68
  v_and_b32 v105, 0xffff0000, v68
  v_lshlrev_b32_e64 v106, 16, v69
  v_and_b32 v107, 0xffff0000, v69
  v_lshlrev_b32_e64 v108, 16, v70
  v_and_b32 v109, 0xffff0000, v70
  v_lshlrev_b32_e64 v110, 16, v71
  v_and_b32 v111, 0xffff0000, v71
  v_pk_add_f32 v[96:97], v[96:97], v[104:105]
  v_pk_add_f32 v[98:99], v[98:99], v[106:107]
  v_pk_add_f32 v[100:101], v[100:101], v[108:109]
  v_pk_add_f32 v[102:103], v[102:103], v[110:111]
  s_waitcnt vmcnt(3)
  v_lshlrev_b32 v104, 16, v72
  v_and_b32 v105, 0xffff0000, v72
  v_lshlrev_b32_e64 v106, 16, v73
  v_and_b32 v107, 0xffff0000, v73
  v_lshlrev_b32_e64 v108, 16, v74
  v_and_b32 v109, 0xffff0000, v74
  v_lshlrev_b32_e64 v110, 16, v75
  v_and_b32 v111, 0xffff0000, v75
  v_pk_add_f32 v[88:89], v[88:89], v[104:105]
  v_pk_add_f32 v[90:91], v[90:91], v[106:107]
  v_pk_add_f32 v[92:93], v[92:93], v[108:109]
  v_pk_add_f32 v[94:95], v[94:95], v[110:111]
  v_lshlrev_b32_e64 v104, 16, v76
  v_and_b32 v105, 0xffff0000, v76
  v_lshlrev_b32_e64 v106, 16, v77
  v_and_b32 v107, 0xffff0000, v77
  v_lshlrev_b32_e64 v108, 16, v78
  v_and_b32 v109, 0xffff0000, v78
  v_lshlrev_b32_e64 v110, 16, v79
  v_and_b32 v111, 0xffff0000, v79
  v_pk_add_f32 v[96:97], v[96:97], v[104:105]
  v_pk_add_f32 v[98:99], v[98:99], v[106:107]
  v_pk_add_f32 v[100:101], v[100:101], v[108:109]
  v_pk_add_f32 v[102:103], v[102:103], v[110:111]
  s_waitcnt vmcnt(1)
  v_lshlrev_b32 v104, 16, v80
  v_and_b32 v105, 0xffff0000, v80
  v_lshlrev_b32_e64 v106, 16, v81
  v_and_b32 v107, 0xffff0000, v81
  v_lshlrev_b32_e64 v108, 16, v82
  v_and_b32 v109, 0xffff0000, v82
  v_lshlrev_b32_e64 v110, 16, v83
  v_and_b32 v111, 0xffff0000, v83
  v_pk_add_f32 v[88:89], v[88:89], v[104:105]
  v_pk_add_f32 v[90:91], v[90:91], v[106:107]
  v_pk_add_f32 v[92:93], v[92:93], v[108:109]
  v_pk_add_f32 v[94:95], v[94:95], v[110:111]
  v_lshlrev_b32_e64 v104, 16, v84
  v_and_b32 v105, 0xffff0000, v84
  v_lshlrev_b32_e64 v106, 16, v85
  v_and_b32 v107, 0xffff0000, v85
  v_lshlrev_b32_e64 v108, 16, v86
  v_and_b32 v109, 0xffff0000, v86
  v_lshlrev_b32_e64 v110, 16, v87
  v_and_b32 v111, 0xffff0000, v87
  v_pk_add_f32 v[96:97], v[96:97], v[104:105]
  v_pk_add_f32 v[98:99], v[98:99], v[106:107]
  v_pk_add_f32 v[100:101], v[100:101], v[108:109]
  v_pk_add_f32 v[102:103], v[102:103], v[110:111]
  s_mul_i32 s57, s3, 3840
  v_lshl_add_u32 v2, v1, 5, s57
  v_lshl_add_u32 v5, v3, 5, s57
  ds_write_b128 v2, v[88:91]
  ds_write_b128 v2, v[92:95] offset:16
  ds_write_b128 v5, v[96:99]
  ds_write_b128 v5, v[100:103] offset:16
  v_min_u32 v2, 239, v0
  v_lshlrev_b32_e64 v2, 4, v2
  s_waitcnt lgkmcnt(0)
  s_barrier
  s_cmp_ge_u32 s3, 4
  s_cbranch_scc1 L_W2
  ds_read_b128 v[32:35], v2 offset:0
  ds_read_b128 v[36:39], v2 offset:3840
  ds_read_b128 v[40:43], v2 offset:7680
  ds_read_b128 v[44:47], v2 offset:11520
  ds_read_b128 v[48:51], v2 offset:15360
  ds_read_b128 v[52:55], v2 offset:19200
  ds_read_b128 v[56:59], v2 offset:23040
  ds_read_b128 v[60:63], v2 offset:26880
  s_lshl_b32 s57, s26, 3
  s_add_u32 s57, s57, s47
  s_mul_i32 s57, s57, 3840
  s_add_u32 s57, s57, 4227072
  s_waitcnt lgkmcnt(0)
  s_nop 0
  v_pk_add_f32 v[32:33], v[32:33], v[48:49]
  v_pk_add_f32 v[34:35], v[34:35], v[50:51]
  v_pk_add_f32 v[36:37], v[36:37], v[52:53]
  v_pk_add_f32 v[38:39], v[38:39], v[54:55]
  v_pk_add_f32 v[40:41], v[40:41], v[56:57]
  v_pk_add_f32 v[42:43], v[42:43], v[58:59]
  v_pk_add_f32 v[44:45], v[44:45], v[60:61]
  v_pk_add_f32 v[46:47], v[46:47], v[62:63]
  v_pk_add_f32 v[32:33], v[32:33], v[40:41]
  v_pk_add_f32 v[34:35], v[34:35], v[42:43]
  v_pk_add_f32 v[36:37], v[36:37], v[44:45]
  v_pk_add_f32 v[38:39], v[38:39], v[46:47]
  v_pk_add_f32 v[32:33], v[32:33], v[36:37]
  v_pk_add_f32 v[34:35], v[34:35], v[38:39]
  v_min_u32 v32, -2, v32
  v_min_u32 v33, -2, v33
  v_min_u32 v34, -2, v34
  v_min_u32 v35, -2, v35
  s_mov_b32 s59, 0
  s_branch L_fl1w
L_fl0w:
  buffer_load_dword v112, v113, s[64:67], 0 offen offset:128 sc1
L_fl1w:
  s_waitcnt vmcnt(0)
  v_cmp_eq_u32 vcc, 0, v112
  s_cbranch_vccz L_fl2w
  s_add_u32 s59, s59, 1
  s_cmp_lt_u32 s59, 131072
  s_cbranch_scc1 L_fl0w
L_fl2w:
  buffer_store_dwordx4 v[32:35], v2, s[36:39], s57 offen sc1
L_W2:
  s_branch L_F
L_X:
  v_mov_b32 v8, 0
  v_mov_b32 v9, 0
  v_mov_b32 v10, 0
  v_mov_b32 v11, 0
  s_mov_b32 s58, 0x3f803f80
  buffer_load_dwordx4 v[32:35], v2, s[32:35], s56 offen
  buffer_load_dwordx4 v[36:39], v5, s[32:35], s56 offen
  s_add_u32 s56, s56, s57
  s_barrier
  buffer_load_dwordx4 v[40:43], v2, s[32:35], s56 offen
  buffer_load_dwordx4 v[44:47], v5, s[32:35], s56 offen
  s_add_u32 s56, s56, s57
  s_barrier
  s_waitcnt vmcnt(6)
  v_dot2c_f32_bf16 v8, s58, v16
  v_dot2c_f32_bf16 v10, v16, v16
  v_dot2c_f32_bf16 v9, s58, v20
  v_dot2c_f32_bf16 v11, v20, v20
  v_dot2c_f32_bf16 v8, s58, v17
  v_dot2c_f32_bf16 v10, v17, v17
  v_dot2c_f32_bf16 v9, s58, v21
  v_dot2c_f32_bf16 v11, v21, v21
  v_dot2c_f32_bf16 v8, s58, v18
  v_dot2c_f32_bf16 v10, v18, v18
  v_dot2c_f32_bf16 v9, s58, v22
  v_dot2c_f32_bf16 v11, v22, v22
  v_dot2c_f32_bf16 v8, s58, v19
  v_dot2c_f32_bf16 v10, v19, v19
  v_dot2c_f32_bf16 v9, s58, v23
  v_dot2c_f32_bf16 v11, v23, v23
  buffer_load_dwordx4 v[48:51], v2, s[32:35], s56 offen
  buffer_load_dwordx4 v[52:55], v5, s[32:35], s56 offen
  s_add_u32 s56, s56, s57
  s_barrier
  s_waitcnt vmcnt(6)
  v_dot2c_f32_bf16 v8, s58, v24
  v_dot2c_f32_bf16 v10, v24, v24
  v_dot2c_f32_bf16 v9, s58, v28
  v_dot2c_f32_bf16 v11, v28, v28
  v_dot2c_f32_bf16 v8, s58, v25
  v_dot2c_f32_bf16 v10, v25, v25
  v_dot2c_f32_bf16 v9, s58, v29
  v_dot2c_f32_bf16 v11, v29, v29
  v_dot2c_f32_bf16 v8, s58, v26
  v_dot2c_f32_bf16 v10, v26, v26
  v_dot2c_f32_bf16 v9, s58, v30
  v_dot2c_f32_bf16 v11, v30, v30
  v_dot2c_f32_bf16 v8, s58, v27
  v_dot2c_f32_bf16 v10, v27, v27
  v_dot2c_f32_bf16 v9, s58, v31
  v_dot2c_f32_bf16 v11, v31, v31
  buffer_load_dwordx4 v[56:59], v2, s[32:35], s56 offen
  buffer_load_dwordx4 v[60:63], v5, s[32:35], s56 offen
  s_add_u32 s56, s56, s57
  s_barrier
  s_waitcnt vmcnt(6)
  v_dot2c_f32_bf16 v8, s58, v32
  v_dot2c_f32_bf16 v10, v32, v32
  v_dot2c_f32_bf16 v9, s58, v36
  v_dot2c_f32_bf16 v11, v36, v36
  v_dot2c_f32_bf16 v8, s58, v33
  v_dot2c_f32_bf16 v10, v33, v33
  v_dot2c_f32_bf16 v9, s58, v37
  v_dot2c_f32_bf16 v11, v37, v37
  v_dot2c_f32_bf16 v8, s58, v34
  v_dot2c_f32_bf16 v10, v34, v34
  v_dot2c_f32_bf16 v9, s58, v38
  v_dot2c_f32_bf16 v11, v38, v38
  v_dot2c_f32_bf16 v8, s58, v35
  v_dot2c_f32_bf16 v10, v35, v35
  v_dot2c_f32_bf16 v9, s58, v39
  v_dot2c_f32_bf16 v11, v39, v39
  buffer_load_dwordx4 v[64:67], v2, s[32:35], s56 offen
  buffer_load_dwordx4 v[68:71], v5, s[32:35], s56 offen
  s_add_u32 s56, s56, s57
  s_barrier
  s_waitcnt vmcnt(6)
  v_dot2c_f32_bf16 v8, s58, v40
  v_dot2c_f32_bf16 v10, v40, v40
  v_dot2c_f32_bf16 v9, s58, v44
  v_dot2c_f32_bf16 v11, v44, v44
  v_dot2c_f32_bf16 v8, s58, v41
  v_dot2c_f32_bf16 v10, v41, v41
  v_dot2c_f32_bf16 v9, s58, v45
  v_dot2c_f32_bf16 v11, v45, v45
  v_dot2c_f32_bf16 v8, s58, v42
  v_dot2c_f32_bf16 v10, v42, v42
  v_dot2c_f32_bf16 v9, s58, v46
  v_dot2c_f32_bf16 v11, v46, v46
  v_dot2c_f32_bf16 v8, s58, v43
  v_dot2c_f32_bf16 v10, v43, v43
  v_dot2c_f32_bf16 v9, s58, v47
  v_dot2c_f32_bf16 v11, v47, v47
  buffer_load_dwordx4 v[72:75], v2, s[32:35], s56 offen
  buffer_load_dwordx4 v[76:79], v5, s[32:35], s56 offen
  s_add_u32 s56, s56, s57
  s_barrier
  s_waitcnt vmcnt(6)
  v_dot2c_f32_bf16 v8, s58, v48
  v_dot2c_f32_bf16 v10, v48, v48
  v_dot2c_f32_bf16 v9, s58, v52
  v_dot2c_f32_bf16 v11, v52, v52
  v_dot2c_f32_bf16 v8, s58, v49
  v_dot2c_f32_bf16 v10, v49, v49
  v_dot2c_f32_bf16 v9, s58, v53
  v_dot2c_f32_bf16 v11, v53, v53
  v_dot2c_f32_bf16 v8, s58, v50
  v_dot2c_f32_bf16 v10, v50, v50
  v_dot2c_f32_bf16 v9, s58, v54
  v_dot2c_f32_bf16 v11, v54, v54
  v_dot2c_f32_bf16 v8, s58, v51
  v_dot2c_f32_bf16 v10, v51, v51
  v_dot2c_f32_bf16 v9, s58, v55
  v_dot2c_f32_bf16 v11, v55, v55
  buffer_load_dwordx4 v[80:83], v2, s[32:35], s56 offen
  buffer_load_dwordx4 v[84:87], v5, s[32:35], s56 offen
  s_waitcnt vmcnt(6)
  v_dot2c_f32_bf16 v8, s58, v56
  v_dot2c_f32_bf16 v10, v56, v56
  v_dot2c_f32_bf16 v9, s58, v60
  v_dot2c_f32_bf16 v11, v60, v60
  v_dot2c_f32_bf16 v8, s58, v57
  v_dot2c_f32_bf16 v10, v57, v57
  v_dot2c_f32_bf16 v9, s58, v61
  v_dot2c_f32_bf16 v11, v61, v61
  v_dot2c_f32_bf16 v8, s58, v58
  v_dot2c_f32_bf16 v10, v58, v58
  v_dot2c_f32_bf16 v9, s58, v62
  v_dot2c_f32_bf16 v11, v62, v62
  v_dot2c_f32_bf16 v8, s58, v59
  v_dot2c_f32_bf16 v10, v59, v59
  v_dot2c_f32_bf16 v9, s58, v63
  v_dot2c_f32_bf16 v11, v63, v63
  s_waitcnt vmcnt(4)
  v_dot2c_f32_bf16 v8, s58, v64
  v_dot2c_f32_bf16 v10, v64, v64
  v_dot2c_f32_bf16 v9, s58, v68
  v_dot2c_f32_bf16 v11, v68, v68
  v_dot2c_f32_bf16 v8, s58, v65
  v_dot2c_f32_bf16 v10, v65, v65
  v_dot2c_f32_bf16 v9, s58, v69
  v_dot2c_f32_bf16 v11, v69, v69
  v_dot2c_f32_bf16 v8, s58, v66
  v_dot2c_f32_bf16 v10, v66, v66
  v_dot2c_f32_bf16 v9, s58, v70
  v_dot2c_f32_bf16 v11, v70, v70
  v_dot2c_f32_bf16 v8, s58, v67
  v_dot2c_f32_bf16 v10, v67, v67
  v_dot2c_f32_bf16 v9, s58, v71
  v_dot2c_f32_bf16 v11, v71, v71
  s_waitcnt vmcnt(2)
  v_dot2c_f32_bf16 v8, s58, v72
  v_dot2c_f32_bf16 v10, v72, v72
  v_dot2c_f32_bf16 v9, s58, v76
  v_dot2c_f32_bf16 v11, v76, v76
  v_dot2c_f32_bf16 v8, s58, v73
  v_dot2c_f32_bf16 v10, v73, v73
  v_dot2c_f32_bf16 v9, s58, v77
  v_dot2c_f32_bf16 v11, v77, v77
  v_dot2c_f32_bf16 v8, s58, v74
  v_dot2c_f32_bf16 v10, v74, v74
  v_dot2c_f32_bf16 v9, s58, v78
  v_dot2c_f32_bf16 v11, v78, v78
  v_dot2c_f32_bf16 v8, s58, v75
  v_dot2c_f32_bf16 v10, v75, v75
  v_dot2c_f32_bf16 v9, s58, v79
  v_dot2c_f32_bf16 v11, v79, v79
  s_waitcnt vmcnt(0)
  v_dot2c_f32_bf16 v8, s58, v80
  v_dot2c_f32_bf16 v10, v80, v80
  v_dot2c_f32_bf16 v9, s58, v84
  v_dot2c_f32_bf16 v11, v84, v84
  v_dot2c_f32_bf16 v8, s58, v81
  v_dot2c_f32_bf16 v10, v81, v81
  v_dot2c_f32_bf16 v9, s58, v85
  v_dot2c_f32_bf16 v11, v85, v85
  v_dot2c_f32_bf16 v8, s58, v82
  v_dot2c_f32_bf16 v10, v82, v82
  v_dot2c_f32_bf16 v9, s58, v86
  v_dot2c_f32_bf16 v11, v86, v86
  v_dot2c_f32_bf16 v8, s58, v83
  v_dot2c_f32_bf16 v10, v83, v83
  v_dot2c_f32_bf16 v9, s58, v87
  v_dot2c_f32_bf16 v11, v87, v87
  s_mov_b32 s36, s24
  s_mov_b32 s37, s25
  s_mov_b32 s38, 268435456
  s_mov_b32 s39, 0x20000
  s_mov_b32 s64, s22
  s_mov_b32 s65, s23
  s_mov_b32 s66, 256
  s_mov_b32 s67, 0x20000
  s_mov_b32 s28, s4
  s_mov_b32 s29, s5
  s_mov_b32 s30, 2359296
  s_mov_b32 s31, 0x20000
  v_mov_b32 v28, 0
  buffer_load_dword v27, v28, s[64:67], 0 offen offset:128 sc1
  v_add_f32_dpp v8, v8, v8 quad_perm:[1,0,3,2] row_mask:0xf bank_mask:0xf
  v_add_f32_dpp v9, v9, v9 quad_perm:[1,0,3,2] row_mask:0xf bank_mask:0xf
  v_add_f32_dpp v10, v10, v10 quad_perm:[1,0,3,2] row_mask:0xf bank_mask:0xf
  v_add_f32_dpp v11, v11, v11 quad_perm:[1,0,3,2] row_mask:0xf bank_mask:0xf
  v_add_f32_dpp v8, v8, v8 quad_perm:[2,3,0,1] row_mask:0xf bank_mask:0xf
  v_add_f32_dpp v9, v9, v9 quad_perm:[2,3,0,1] row_mask:0xf bank_mask:0xf
  v_add_f32_dpp v10, v10, v10 quad_perm:[2,3,0,1] row_mask:0xf bank_mask:0xf
  v_add_f32_dpp v11, v11, v11 quad_perm:[2,3,0,1] row_mask:0xf bank_mask:0xf
  v_add_f32_dpp v8, v8, v8 row_half_mirror row_mask:0xf bank_mask:0xf
  v_add_f32_dpp v9, v9, v9 row_half_mirror row_mask:0xf bank_mask:0xf
  v_add_f32_dpp v10, v10, v10 row_half_mirror row_mask:0xf bank_mask:0xf
  v_add_f32_dpp v11, v11, v11 row_half_mirror row_mask:0xf bank_mask:0xf
  v_and_b32 v5, 1, v1
  v_cmp_eq_u32_e64 vcc, 1, v5
  s_nop 1
  v_cndmask_b32 v16, v8, v9, vcc
  v_cndmask_b32 v18, v10, v11, vcc
  v_mul_f32 v16, 0x3ae38e39, v16
  v_mul_f32 v18, 0x3ae38e39, v18
  v_fma_f32 v18, -v16, v16, v18
  v_max_f32_e64 v18, 0, v18
  v_cvt_pk_bf16_f32 v20, v16, v18
  v_lshlrev_b32_e64 v16, 16, v20
  v_and_b32 v18, 0xffff0000, v20
  v_add_f32 v18, 0x3727c5ac, v18
  v_cvt_pk_bf16_f32 v18, v18, v18
  v_and_b32 v18, 0xffff0000, v18
  v_sqrt_f32 v18, v18
  s_nop 0
  v_cvt_pk_bf16_f32 v18, v18, v18
  v_and_b32 v18, 0xffff0000, v18
  v_rcp_f32_e64 v18, v18
  v_lshl_add_u32 v20, v5, 3, v7
  v_lshlrev_b32_e64 v20, 2, v20
  v_mul_f32 v18, 0x3fb8aa3b, v18
  v_mul_f32_e64 v19, -v16, v18
  v_min_u32 v18, -2, v18
  v_min_u32_e64 v19, -2, v19
  s_lshl_b32 s56, s55, 6
  s_lshl_b32 s57, s46, 14
  s_add_u32 s56, s56, s57
  s_add_u32 s56, s56, 4194304
  s_add_u32 s57, s56, 8192
  s_mov_b32 s59, 0
  s_branch L_fl1x
L_fl0x:
  buffer_load_dword v27, v28, s[64:67], 0 offen offset:128 sc1
L_fl1x:
  s_waitcnt vmcnt(0)
  v_cmp_eq_u32 vcc, 0, v27
  s_cbranch_vccz L_fl2x
  s_add_u32 s59, s59, 1
  s_cmp_lt_u32 s59, 131072
  s_cbranch_scc1 L_fl0x
L_fl2x:
  s_mov_b32 s58, 0x03030303
  s_mov_b32 s59, 0x03030303
  s_mov_b64 exec, s[58:59]
  buffer_store_dword v18, v20, s[36:39], s56 offen sc1
  buffer_store_dword v19, v20, s[36:39], s57 offen sc1
  s_mov_b64 exec, -1
  s_cmp_eq_u32 s27, 24
  s_cbranch_scc1 L_F
  s_mov_b32 s68, s8
  s_mov_b32 s69, s9
  s_mov_b32 s70, 663552
  s_mov_b32 s71, 0x20000
  s_sub_u32 s56, s27, 25
  s_lshl_b32 s56, s56, 3
  s_add_u32 s56, s56, s3
  s_lshl_b32 s56, s56, 13
  v_lshlrev_b32 v2, 7, v1
  s_cmp_lt_u32 s27, 27
  s_cbranch_scc1 L_HS3
  s_endpgm
L_HS3:
  s_sub_u32 s53, s27, 9
  s_cmp_lt_u32 s3, 4
  s_cbranch_scc1 L_HS3b
  s_cmp_ge_u32 s53, 9
  s_cselect_b32 s57, 9, 0
  s_sub_u32 s63, s53, s57
  v_lshrrev_b32 v2, 3, v1
  v_and_b32_e64 v3, 7, v1
  v_bfe_u32 v4, v1, 4, 2
  v_lshlrev_b32 v4, 1, v4
  v_xor_b32 v3, v3, v4
  v_lshlrev_b32 v3, 4, v3
  s_lshl_b32 s57, s63, 7
  v_add_u32 v3, s57, v3
  v_lshrrev_b32 v4, 2, v2
  v_and_b32_e64 v5, 3, v2
  v_mad_u32_u24 v6, v4, 10, v5
  s_and_b32 s57, s54, 1
  s_mul_i32 s58, s57, 18
  s_lshr_b32 s59, s54, 1
  s_lshl_b32 s42, s59, 2
  s_add_u32 s58, s58, s42
  v_add_u32 v6, s58, v6
  v_mul_u32_u24 v6, 1152, v6
  v_add_u32_e64 v20, v6, v3
  v_mul_u32_u24 v4, 72, v4
  v_bfe_u32 v5, v2, 1, 1
  v_mad_u32_u24 v4, v5, 18, v4
  v_and_b32 v5, 1, v2
  v_add_u32 v4, v4, v5
  s_mul_i32 s57, s57, 144
  s_mul_i32 s59, s59, 36
  s_add_u32 s57, s57, s59
  s_add_u32 s57, s57, 8
  v_add_u32 v4, s57, v4
  v_mul_u32_u24 v4, 1152, v4
  v_add_u32 v21, v4, v3
  v_and_b32 v3, 7, v1
  v_xor_b32_e64 v3, v3, v2
  v_mul_u32_u24 v4, 1152, v2
  v_lshl_add_u32 v29, v3, 4, v4
  s_cmp_ge_u32 s53, 9
  s_cselect_b32 s57, 16, 0
  s_lshl_b32 s49, s26, 5
  s_add_u32 s49, s49, s57
  s_add_u32 s49, s49, s54
  s_mul_i32 s49, s49, 9216
  s_lshl_b32 s57, s63, 7
  s_add_u32 s49, s49, s57
  s_mov_b32 s68, s8
  s_mov_b32 s69, s9
  s_mov_b32 s70, 663552
  s_mov_b32 s71, 0x20000
  s_lshl_b32 s42, s54, 10
  s_mul_i32 s40, s63, 0
  s_and_b32 s40, s40, 15
  s_mul_i32 s40, s40, 41472
L_wodh:
  s_mov_b32 m0, s42
  s_nop 0
  s_add_u32 s42, s42, 4096
  buffer_load_dwordx4 v20, s[68:71], s40 offen lds
  s_add_u32 s40, s40, 41472
  s_cmp_eq_u32 s40, 663552
  s_cselect_b32 s40, 0, s40
  s_cmp_lt_u32 s42, 65536
  s_cbranch_scc1 L_wodh
  s_mov_b32 m0, s42
  s_add_u32 s42, s42, 4096
  buffer_load_dwordx4 v21, s[68:71], 0 offen lds
  s_mov_b32 m0, s42
  s_mov_b32 s40, 331776
  buffer_load_dwordx4 v21, s[68:71], s40 offen lds
  s_lshl_b32 s42, s54, 10
  s_add_u32 m0, s42, 137216
  s_add_u32 s40, s49, 0
  buffer_load_dwordx4 v29, s[28:31], s40 offen lds
  s_add_u32 m0, s42, 141312
  s_add_u32 s40, s49, 36864
  buffer_load_dwordx4 v29, s[28:31], s40 offen lds
  s_add_u32 m0, s42, 145408
  s_add_u32 s40, s49, 73728
  buffer_load_dwordx4 v29, s[28:31], s40 offen lds
  s_add_u32 m0, s42, 149504
  s_add_u32 s40, s49, 110592
  buffer_load_dwordx4 v29, s[28:31], s40 offen lds
  s_cmp_lg_u32 s54, 3
  s_cbranch_scc1 L_HS3b
  s_mov_b32 s59, 0
L_fl0h:
  s_sleep 4
  buffer_load_dword v27, v28, s[64:67], 0 offen offset:132 sc1
L_fl1h:
  s_waitcnt vmcnt(0)
  v_cmp_eq_u32 vcc, 0, v27
  s_cbranch_vccz L_fl2h
  s_add_u32 s59, s59, 1
  s_cmp_lt_u32 s59, 131072
  s_cbranch_scc1 L_fl0h
L_fl2h:
  s_mov_b32 s68, s12
  s_mov_b32 s69, s13
  s_mov_b32 s70, 1152
  s_mov_b32 s71, 0x20000
  v_lshlrev_b32 v2, 2, v1
  buffer_load_dword v30, v2, s[68:71], 0 offen offset:0
  buffer_load_dword v31, v2, s[68:71], 0 offen offset:256
  buffer_load_dword v32, v2, s[68:71], 0 offen offset:512
  buffer_load_dword v33, v2, s[68:71], 0 offen offset:768
  buffer_load_dword v34, v2, s[68:71], 0 offen offset:1024
  v_mov_b32_e64 v3, 0
  s_mov_b32 s57, 0x3f803f80
  s_waitcnt vmcnt(0)
  s_nop 0
  v_add_u32 v2, 158272, v2
  ds_write_b32 v2, v30 offset:0
  ds_write_b32 v2, v31 offset:256
  ds_write_b32 v2, v32 offset:512
  ds_write_b32 v2, v33 offset:768
  ds_write_b32 v2, v34 offset:1024
  v_dot2c_f32_bf16 v3, s57, v30
  v_dot2c_f32_bf16 v3, s57, v31
  v_dot2c_f32_bf16 v3, s57, v32
  v_dot2c_f32_bf16 v3, s57, v33
  v_dot2c_f32_bf16 v3, s57, v34
  s_nop 2
  v_add_f32_dpp v3, v3, v3 quad_perm:[1,0,3,2] row_mask:0xf bank_mask:0xf
  s_nop 1
  v_add_f32_dpp v3, v3, v3 quad_perm:[2,3,0,1] row_mask:0xf bank_mask:0xf
  s_nop 1
  v_add_f32_dpp v3, v3, v3 row_half_mirror row_mask:0xf bank_mask:0xf
  s_nop 1
  v_add_f32_dpp v3, v3, v3 row_mirror row_mask:0xf bank_mask:0xf
  v_mov_b32 v4, v3
  s_nop 1
  v_permlane16_swap_b32 v3, v4
  v_add_f32 v3, v3, v4
  v_mov_b32 v4, v3
  s_nop 1
  v_permlane32_swap_b32 v3, v4
  v_add_f32_e64 v3, v3, v4
  v_mov_b32 v4, 158208
  ds_write_b32 v4, v3
  s_getreg_b32 s57, hwreg(HW_REG_XCC_ID)
  s_and_b32 s57, s57, 15
  v_mov_b32 v36, s57
  v_mov_b32_e64 v37, 0
  s_cmp_ge_u32 s53, 9
  s_cselect_b32 s57, 128, 0
  s_lshl_b32 s58, s26, 8
  s_add_u32 s57, s57, s58
  s_lshl_b32 s58, s63, 2
  s_add_u32 s57, s57, s58
  s_add_u32 s57, s57, 3065856
  s_mov_b64 exec, 1
  buffer_store_dword v36, v37, s[36:39], s57 offen sc1
  s_mov_b64 exec, -1
L_HS3b:
  s_waitcnt vmcnt(0) lgkmcnt(0)
  s_barrier
  s_branch L_s3pre
L_R:
  v_mov_b32 v8, -1
  v_mov_b32 v9, -1
  v_mov_b32 v10, -1
  v_mov_b32 v11, -1
  v_lshlrev_b32 v12, 4, v1
  s_lshl_b32 s48, s26, 2
  s_add_u32 s48, s48, s47
  s_sub_u32 s48, s48, 12
  s_lshl_b32 s57, s48, 3
  s_add_u32 s57, s57, s3
  s_lshl_b32 s56, s57, 11
  s_add_u32 s56, s56, 4194304
  s_mul_i32 s57, s57, 14336
  s_add_u32 s58, s57, 14336
  s_waitcnt lgkmcnt(0)
  s_mov_b32 s36, s24
  s_mov_b32 s37, s25
  s_mov_b32 s38, 268435456
  s_mov_b32 s39, 0x20000
  s_mov_b32 s64, s22
  s_mov_b32 s65, s23
  s_nop 0
  s_mov_b32 s66, 256
  s_mov_b32 s67, 0x20000
  buffer_store_dwordx4 v[8:11], v12, s[36:39], s56 offen sc1
  buffer_store_dwordx4 v[8:11], v12, s[36:39], s56 offen offset:1024 sc1
  s_mov_b32 s28, s4
  s_mov_b32 s29, s5
  s_mov_b32 s30, 2359296
  s_mov_b32 s31, 0x20000
  s_mov_b32 s32, s6
  s_mov_b32 s33, s7
  s_mov_b32 s34, 1990656
  s_mov_b32 s35, 0x20000
  s_mov_b32 s68, s8
  s_mov_b32 s69, s9
  s_mov_b32 s70, 663552
  s_mov_b32 s71, 0x20000
  s_cmp_ge_u32 s3, 4
  s_cbranch_scc1 L_Rw
  v_mul_u32_u24 v2, 1152, v1
  s_mul_i32 s55, s48, 73728
  s_lshl_b32 s59, s3, 7
  s_add_u32 s55, s55, s59
  s_nop 0
  v_lshlrev_b32 v2, 7, v1
  s_mul_i32 s55, s48, 3
  s_add_u32 s55, s55, s3
  s_lshl_b32 s55, s55, 13
  s_cmp_eq_u32 s3, 3
  s_cselect_b32 s55, 0x100000, s55
  buffer_load_dword v100, v2, s[68:71], s55 offen
  s_waitcnt vmcnt(1)
  s_branch L_Rx
L_Rw:
  v_min_u32 v2, 53, v1
  v_lshlrev_b32_e64 v2, 7, v2
  s_lshl_b32 s55, s3, 5
  s_add_u32 s55, s55, s48
  s_add_u32 s55, s55, 32
  s_mul_i32 s55, s55, 6912
  s_nop 0
  s_waitcnt vmcnt(0)
L_Rx:
  s_barrier
  s_cmp_lg_u32 s3, 0
  s_cbranch_scc1 L_R21
  v_mov_b32 v20, 1
  v_mov_b32 v21, 0
  s_mov_b64 exec, 1
  buffer_atomic_add v20, v21, s[64:67], 0 offen offset:0 sc0
  s_waitcnt vmcnt(0)
  v_cmp_eq_u32_e64 vcc, 31, v20
  s_cbranch_vccz L_arq
  buffer_store_dword v20, v21, s[64:67], 0 offen offset:128 sc1
L_arq:
  s_mov_b64 exec, -1
L_R21:
  s_barrier
L_R2:
  buffer_store_dwordx4 v[8:11], v12, s[36:39], s57 offen sc1
  s_add_u32 s57, s57, 1024
  s_cmp_lt_u32 s57, s58
  s_cbranch_scc1 L_R2
L_R4:
  s_waitcnt vmcnt(0)
  s_barrier
  s_cmp_lg_u32 s3, 0
  s_cbranch_scc1 L_R3
  v_mov_b32 v20, 1
  v_mov_b32_e64 v21, 0
  s_mov_b64 exec, 1
  buffer_atomic_add v20, v21, s[64:67], 0 offen offset:4 sc0
  s_waitcnt vmcnt(0)
  v_cmp_eq_u32_e64 vcc, 31, v20
  s_cbranch_vccz L_arr
  buffer_store_dword v20, v21, s[64:67], 0 offen offset:132 sc1
L_arr:
  s_mov_b64 exec, -1
L_R3:
  s_mov_b32 s68, s8
  s_mov_b32 s69, s9
  s_mov_b32 s70, 663552
  s_mov_b32 s71, 0x20000
  s_sub_u32 s56, s27, 28
  s_lshl_b32 s56, s56, 3
  s_add_u32 s56, s56, s3
  s_lshl_b32 s56, s56, 13
  v_lshlrev_b32_e64 v2, 7, v1
  s_barrier
  buffer_load_dword v100, v2, s[68:71], s56 offen
  s_add_u32 s56, s56, 262144
  s_barrier
  buffer_load_dword v100, v2, s[68:71], s56 offen
  s_add_u32 s56, s56, 262144
  s_barrier
  buffer_load_dword v100, v2, s[68:71], s56 offen
  s_add_u32 s56, s56, 262144
  s_endpgm
L_F:
  s_mov_b32 s32, s18
  s_mov_b32 s33, s19
  s_mov_b32 s34, 5308416
  s_mov_b32 s35, 0x20000
  s_mov_b32 s68, s14
  s_mov_b32 s69, s15
  s_mov_b32 s70, 5308416
  s_mov_b32 s71, 0x20000
  s_mul_i32 s48, s26, 9
  s_add_u32 s48, s48, s47
  s_and_b32 s56, s3, 1
  s_lshl_b32 s56, s56, 4
  s_bfe_u32 s57, s3, 0x10001
  s_lshl_b32 s57, s57, 2
  s_add_u32 s56, s56, s57
  s_lshr_b32 s57, s3, 2
  s_lshl_b32 s57, s57, 5
  s_add_u32 s55, s56, s57
  s_lshl_b32 s57, s48, 6
  s_add_u32 s56, s55, s57
  s_mul_i32 s56, s56, 1152
  s_mul_i32 s57, s3, 9216
  v_lshlrev_b32 v2, 4, v1
  v_lshrrev_b32 v3, 5, v1
  v_mul_u32_u24 v3, 4608, v3
  v_add_u32_e64 v3, v3, v2
  s_add_u32 m0, s57, 73728
  s_add_u32 s58, s56, 0
  s_nop 0
  buffer_load_dwordx4 v2, s[32:35], s58 offen nt lds
  s_add_u32 m0, s57, 74752
  s_add_u32 s58, s56, 1024
  buffer_load_dwordx4 v2, s[32:35], s58 offen nt lds
  s_add_u32 m0, s57, 75776
  s_add_u32 s58, s56, 2048
  buffer_load_dwordx4 v2, s[32:35], s58 offen nt lds
  s_add_u32 m0, s57, 76800
  s_add_u32 s58, s56, 3072
  buffer_load_dwordx4 v2, s[32:35], s58 offen nt lds
  s_add_u32 m0, s57, 77824
  s_add_u32 s58, s56, 4096
  buffer_load_dwordx4 v3, s[32:35], s58 offen nt lds
  s_add_u32 m0, s57, 78848
  s_add_u32 s58, s56, 9728
  buffer_load_dwordx4 v2, s[32:35], s58 offen nt lds
  s_add_u32 m0, s57, 79872
  s_add_u32 s58, s56, 10752
  buffer_load_dwordx4 v2, s[32:35], s58 offen nt lds
  s_add_u32 m0, s57, 80896
  s_add_u32 s58, s56, 11776
  buffer_load_dwordx4 v2, s[32:35], s58 offen nt lds
  s_add_u32 m0, s57, 81920
  s_add_u32 s58, s56, 12800
  buffer_load_dwordx4 v2, s[32:35], s58 offen nt lds
  v_lshrrev_b32 v2, 3, v1
  v_and_b32 v3, 7, v1
  v_xor_b32 v3, v3, v2
  v_lshlrev_b32 v3, 4, v3
  v_lshrrev_b32 v4, 2, v2
  v_and_b32 v5, 3, v2
  v_lshl_add_u32 v4, v4, 3, v5
  v_add_u32_e64 v4, s55, v4
  v_mul_u32_u24 v4, 9216, v4
  v_add_u32_e64 v4, v4, v3
  s_barrier
  s_lshl_b32 s56, s48, 7
  s_lshl_b32 s57, s3, 10
  s_add_u32 s57, s57, 0
  s_mov_b32 s58, 0
L_Flg:
  s_mov_b32 m0, s57
  s_add_u32 s57, s57, 8192
  buffer_load_dwordx4 v4, s[68:71], s56 offen nt lds
  s_add_u32 s56, s56, 589824
  s_add_u32 s58, s58, 1
  s_cmp_lt_u32 s58, 9
  s_cbranch_scc1 L_Flg
  v_lshrrev_b32 v2, 2, v13
  v_lshl_add_u32 v2, v14, 2, v2
  v_mul_u32_u24 v2, 1152, v2
  v_and_b32_e64 v3, 3, v13
  v_lshl_add_u32 v2, v3, 3, v2
  s_mul_i32 s56, s54, 288
  s_add_u32 s56, s56, 73728
  v_add_u32_e64 v5, s56, v2
  s_mov_b32 s68, s16
  s_mov_b32 s69, s17
  s_waitcnt vmcnt(9)
  s_barrier
  s_cmp_ge_u32 s3, 4
  s_cbranch_scc1 L_Fa
  ds_read_b64_tr_b16 v[160:161], v5 offset:0
  ds_read_b64_tr_b16 v[162:163], v5 offset:18432
  ds_read_b64_tr_b16 v[164:165], v5 offset:36864
  ds_read_b64_tr_b16 v[166:167], v5 offset:55296
  ds_read_b64_tr_b16 v[168:169], v5 offset:32
  ds_read_b64_tr_b16 v[170:171], v5 offset:18464
  ds_read_b64_tr_b16 v[172:173], v5 offset:36896
  ds_read_b64_tr_b16 v[174:175], v5 offset:55328
  ds_read_b64_tr_b16 v[176:177], v5 offset:64
  ds_read_b64_tr_b16 v[178:179], v5 offset:18496
  ds_read_b64_tr_b16 v[180:181], v5 offset:36928
  ds_read_b64_tr_b16 v[182:183], v5 offset:55360
  ds_read_b64_tr_b16 v[184:185], v5 offset:96
  ds_read_b64_tr_b16 v[186:187], v5 offset:18528
  ds_read_b64_tr_b16 v[188:189], v5 offset:36960
  ds_read_b64_tr_b16 v[190:191], v5 offset:55392
  ds_read_b64_tr_b16 v[192:193], v5 offset:128
  ds_read_b64_tr_b16 v[194:195], v5 offset:18560
  ds_read_b64_tr_b16 v[196:197], v5 offset:36992
  ds_read_b64_tr_b16 v[198:199], v5 offset:55424
  ds_read_b64_tr_b16 v[200:201], v5 offset:160
  ds_read_b64_tr_b16 v[202:203], v5 offset:18592
  ds_read_b64_tr_b16 v[204:205], v5 offset:37024
  ds_read_b64_tr_b16 v[206:207], v5 offset:55456
  ds_read_b64_tr_b16 v[208:209], v5 offset:192
  ds_read_b64_tr_b16 v[210:211], v5 offset:18624
  ds_read_b64_tr_b16 v[212:213], v5 offset:37056
  ds_read_b64_tr_b16 v[214:215], v5 offset:55488
  ds_read_b64_tr_b16 v[216:217], v5 offset:224
  ds_read_b64_tr_b16 v[218:219], v5 offset:18656
  ds_read_b64_tr_b16 v[220:221], v5 offset:37088
  ds_read_b64_tr_b16 v[222:223], v5 offset:55520
  ds_read_b64_tr_b16 v[224:225], v5 offset:256
  ds_read_b64_tr_b16 v[226:227], v5 offset:18688
  ds_read_b64_tr_b16 v[228:229], v5 offset:37120
  ds_read_b64_tr_b16 v[230:231], v5 offset:55552
L_Fa:
  s_waitcnt lgkmcnt(0)
  s_barrier
  s_lshl_b32 s56, s48, 7
  s_lshl_b32 s57, s3, 10
  s_add_u32 s57, s57, 73728
  s_mov_b32 s58, 0
L_Flu:
  s_mov_b32 m0, s57
  s_add_u32 s57, s57, 8192
  buffer_load_dwordx4 v4, s[68:71], s56 offen nt lds
  s_add_u32 s56, s56, 589824
  s_add_u32 s58, s58, 1
  s_cmp_lt_u32 s58, 9
  s_cbranch_scc1 L_Flu
  v_lshrrev_b32 v2, 2, v13
  v_lshl_add_u32 v2, v14, 2, v2
  v_and_b32 v3, 7, v2
  s_lshl_b32 s56, s54, 1
  v_xor_b32 v3, s56, v3
  v_lshlrev_b32 v3, 4, v3
  v_lshl_add_u32 v3, v2, 7, v3
  v_and_b32_e64 v4, 1, v13
  v_lshl_add_u32 v3, v4, 3, v3
  v_bfe_u32 v4, v13, 1, 1
  s_mov_b32 s56, 73728
  v_mad_u32_u24 v5, v4, s56, v3
  v_xor_b32_e64 v6, 16, v5
  v_add_u32 v7, 0x9000, v5
  v_add_u32 v8, 0x9000, v6
  v_mov_b32_e64 v249, 0
  s_mov_b32 s59, 0
L_fl0f:
  s_sleep 4
  buffer_load_dword v250, v249, s[64:67], 0 offen offset:132 sc1
L_fl1f:
  s_waitcnt vmcnt(0)
  v_cmp_eq_u32 vcc, 0, v250
  s_cbranch_vccz L_fl2f
  s_add_u32 s59, s59, 1
  s_cmp_lt_u32 s59, 131072
  s_cbranch_scc1 L_fl0f
L_fl2f:
  s_waitcnt vmcnt(0)
  s_barrier
  s_cmp_ge_u32 s3, 4
  s_cbranch_scc1 L_Fb
  s_nop 0
  ds_read_b64_tr_b16 v[16:17], v5 offset:0
  ds_read_b64_tr_b16 v[18:19], v5 offset:2048
  ds_read_b64_tr_b16 v[20:21], v6 offset:0
  ds_read_b64_tr_b16 v[22:23], v6 offset:2048
  ds_read_b64_tr_b16 v[24:25], v5 offset:4096
  ds_read_b64_tr_b16 v[26:27], v5 offset:6144
  ds_read_b64_tr_b16 v[28:29], v6 offset:4096
  ds_read_b64_tr_b16 v[30:31], v6 offset:6144
  ds_read_b64_tr_b16 v[32:33], v5 offset:8192
  ds_read_b64_tr_b16 v[34:35], v5 offset:10240
  ds_read_b64_tr_b16 v[36:37], v6 offset:8192
  ds_read_b64_tr_b16 v[38:39], v6 offset:10240
  ds_read_b64_tr_b16 v[40:41], v5 offset:12288
  ds_read_b64_tr_b16 v[42:43], v5 offset:14336
  ds_read_b64_tr_b16 v[44:45], v6 offset:12288
  ds_read_b64_tr_b16 v[46:47], v6 offset:14336
  ds_read_b64_tr_b16 v[48:49], v5 offset:16384
  ds_read_b64_tr_b16 v[50:51], v5 offset:18432
  ds_read_b64_tr_b16 v[52:53], v6 offset:16384
  ds_read_b64_tr_b16 v[54:55], v6 offset:18432
  ds_read_b64_tr_b16 v[56:57], v5 offset:20480
  ds_read_b64_tr_b16 v[58:59], v5 offset:22528
  ds_read_b64_tr_b16 v[60:61], v6 offset:20480
  ds_read_b64_tr_b16 v[62:63], v6 offset:22528
  ds_read_b64_tr_b16 v[64:65], v5 offset:24576
  ds_read_b64_tr_b16 v[66:67], v5 offset:26624
  ds_read_b64_tr_b16 v[68:69], v6 offset:24576
  ds_read_b64_tr_b16 v[70:71], v6 offset:26624
  ds_read_b64_tr_b16 v[72:73], v5 offset:28672
  ds_read_b64_tr_b16 v[74:75], v5 offset:30720
  ds_read_b64_tr_b16 v[76:77], v6 offset:28672
  ds_read_b64_tr_b16 v[78:79], v6 offset:30720
  ds_read_b64_tr_b16 v[80:81], v5 offset:32768
  ds_read_b64_tr_b16 v[82:83], v5 offset:34816
  ds_read_b64_tr_b16 v[84:85], v6 offset:32768
  ds_read_b64_tr_b16 v[86:87], v6 offset:34816
  ds_read_b64_tr_b16 v[88:89], v7 offset:0
  ds_read_b64_tr_b16 v[90:91], v7 offset:2048
  ds_read_b64_tr_b16 v[92:93], v8 offset:0
  ds_read_b64_tr_b16 v[94:95], v8 offset:2048
  ds_read_b64_tr_b16 v[96:97], v7 offset:4096
  ds_read_b64_tr_b16 v[98:99], v7 offset:6144
  ds_read_b64_tr_b16 v[100:101], v8 offset:4096
  ds_read_b64_tr_b16 v[102:103], v8 offset:6144
  ds_read_b64_tr_b16 v[104:105], v7 offset:8192
  ds_read_b64_tr_b16 v[106:107], v7 offset:10240
  ds_read_b64_tr_b16 v[108:109], v8 offset:8192
  ds_read_b64_tr_b16 v[110:111], v8 offset:10240
  ds_read_b64_tr_b16 v[112:113], v7 offset:12288
  ds_read_b64_tr_b16 v[114:115], v7 offset:14336
  ds_read_b64_tr_b16 v[116:117], v8 offset:12288
  ds_read_b64_tr_b16 v[118:119], v8 offset:14336
  ds_read_b64_tr_b16 v[120:121], v7 offset:16384
  ds_read_b64_tr_b16 v[122:123], v7 offset:18432
  ds_read_b64_tr_b16 v[124:125], v8 offset:16384
  ds_read_b64_tr_b16 v[126:127], v8 offset:18432
  ds_read_b64_tr_b16 v[128:129], v7 offset:20480
  ds_read_b64_tr_b16 v[130:131], v7 offset:22528
  ds_read_b64_tr_b16 v[132:133], v8 offset:20480
  ds_read_b64_tr_b16 v[134:135], v8 offset:22528
  ds_read_b64_tr_b16 v[136:137], v7 offset:24576
  ds_read_b64_tr_b16 v[138:139], v7 offset:26624
  ds_read_b64_tr_b16 v[140:141], v8 offset:24576
  ds_read_b64_tr_b16 v[142:143], v8 offset:26624
  ds_read_b64_tr_b16 v[144:145], v7 offset:28672
  ds_read_b64_tr_b16 v[146:147], v7 offset:30720
  ds_read_b64_tr_b16 v[148:149], v8 offset:28672
  ds_read_b64_tr_b16 v[150:151], v8 offset:30720
  ds_read_b64_tr_b16 v[152:153], v7 offset:32768
  ds_read_b64_tr_b16 v[154:155], v7 offset:34816
  ds_read_b64_tr_b16 v[156:157], v8 offset:32768
  ds_read_b64_tr_b16 v[158:159], v8 offset:34816
L_Fb:
  s_waitcnt lgkmcnt(0)
  s_cmp_lt_u32 s3, 4
  s_cbranch_scc1 L_Fd
  s_sub_u32 s49, s2, 128
  s_cmp_lg_u32 s3, 7
  s_cbranch_scc1 L_fin
  s_cmp_ge_u32 s49, 36
  s_cbranch_scc1 L_fin
L_Fd:
  v_lshlrev_b32 v7, 4, v0
  v_and_b32_e64 v2, 1, v13
  v_mul_u32_u24 v8, 1168, v2
  v_lshl_add_u32 v8, v14, 4, v8
  v_add_u32 v8, 147456, v8
  v_lshlrev_b32_e64 v9, 7, v2
  v_lshl_add_u32 v10, v14, 4, v9
  v_add_u32 v10, 150016, v10
  v_lshl_add_u32 v9, v14, 3, v9
  s_lshl_b32 s56, s54, 5
  s_add_u32 s56, s56, 150016
  v_add_u32 v9, s56, v9
  v_and_b32 v3, 6, v13
  v_add_u32 v9, v9, v3
  v_lshrrev_b32_e64 v3, 3, v13
  v_lshl_add_u32 v9, v3, 4, v9
  s_mov_b32 s46, 0xcccccccc
  s_mov_b32 s47, 0xcccccccc
  s_mov_b32 s52, 0xf0f0f0f0
  s_mov_b32 s53, 0xf0f0f0f0
  s_mov_b32 s34, 0xff00ff00
  s_mov_b32 s35, 0xff00ff00
  v_mul_u32_u24 v11, 2304, v2
  v_lshl_add_u32 v11, v14, 4, v11
  v_bfe_u32 v3, v13, 1, 2
  v_lshl_add_u32 v15, v3, 6, v11
  v_lshrrev_b32_e64 v3, 3, v13
  v_lshl_or_b32 v15, v3, 31, v15
  v_cmp_lt_u32 s[40:41], 1, v13
  s_nop 1
  v_cndmask_b32_e64 v3, 0, 1, s[40:41]
  v_lshl_or_b32 v11, v3, 31, v11
  v_lshlrev_b32_e64 v12, 7, v13
  s_movk_i32 s58, 72
  v_cmp_le_u32 s[44:45], s58, v0
  s_nop 1
  v_cndmask_b32_e64 v4, 0, 1, s[44:45]
  v_mul_u32_u24 v5, 1152, v4
  v_sub_u32 v5, v7, v5
  v_lshl_add_u32 v6, v4, 4, v7
  v_add_u32 v6, 147456, v6
  s_mul_i32 s60, s48, 4608
  s_mul_i32 s56, s54, 576
  s_add_u32 s60, s60, s56
  s_add_u32 s60, s60, 3141632
  s_lshl_b32 s57, s26, 11
  s_add_u32 s57, s57, 3047424
  s_mov_b32 s59, 0
  s_movk_i32 s58, 144
  s_movk_i32 s55, 2304
  v_cmp_gt_u32 s[42:43], s58, v0
  s_cmp_lg_u32 s3, 3
  s_cbranch_scc1 L_k0
  s_getpc_b64 s[40:41]
L_pc1:
  v_lshlrev_b32_e64 v2, 7, v1
  v_min_u32 v2, L_codeend-L_pc1-4, v2
  global_load_dword v2, v2, s[40:41]
  s_waitcnt vmcnt(0)
  s_branch L_f2
L_k0:
  buffer_load_dwordx2 v[232:233], v12, s[36:39], s57 offen sc1
  s_waitcnt vmcnt(0)
  v_max_u32 v2, v232, v233
  v_cmp_eq_u32 vcc, -1, v2
  s_cbranch_vccz L_k1
  s_sleep 1
  s_add_u32 s59, s59, 1
  s_cmp_lt_u32 s59, 131072
  s_cbranch_scc1 L_k0
L_k1:
  v_max_u32_dpp v236, v232, v232 quad_perm:[1,0,3,2] row_mask:0xf bank_mask:0xf
  s_nop 1
  v_max_u32_dpp v236, v236, v236 quad_perm:[2,3,0,1] row_mask:0xf bank_mask:0xf
  s_nop 1
  v_max_u32_dpp v236, v236, v236 row_half_mirror row_mask:0xf bank_mask:0xf
  s_nop 1
  v_max_u32_dpp v236, v236, v236 row_mirror row_mask:0xf bank_mask:0xf
  v_cmp_eq_u32 s[40:41], v232, v236
  s_nop 1
  v_cndmask_b32_e64 v2, v232, v233, s[40:41]
  s_nop 1
  v_max_u32_dpp v237, v2, v2 quad_perm:[1,0,3,2] row_mask:0xf bank_mask:0xf
  s_nop 1
  v_max_u32_dpp v237, v237, v237 quad_perm:[2,3,0,1] row_mask:0xf bank_mask:0xf
  s_nop 1
  v_max_u32_dpp v237, v237, v237 row_half_mirror row_mask:0xf bank_mask:0xf
  s_nop 1
  v_max_u32_dpp v237, v237, v237 row_mirror row_mask:0xf bank_mask:0xf
  v_not_b32 v2, v236
  v_not_b32_e64 v3, v237
  v_bfe_u32 v2, v2, 7, 4
  v_bfe_u32 v3, v3, 7, 4
  v_cmp_eq_u32 s[40:41], v2, v3
  v_lshlrev_b32 v2, 1, v2
  v_lshlrev_b32 v3, 1, v3
  v_addc_co_u32_e64 v3, s[40:41], 0, v3, s[40:41]
  s_cmp_eq_u32 s3, 7
  s_cbranch_scc1 L_fz
  v_cndmask_b32_e64 v2, v2, v3, s[44:45]
  v_mad_u32_u24 v2, v2, s55, v5
  s_mov_b64 exec, s[42:43]
  s_mov_b32 s57, 3067904
  s_mov_b32 s59, 0
L_f0:
  buffer_load_dwordx4 v[232:235], v2, s[36:39], s57 offen sc1
  s_waitcnt vmcnt(0)
  v_max3_u32 v3, v232, v233, v234
  v_max_u32 v3, v3, v235
  v_cmp_eq_u32_e64 vcc, -1, v3
  s_cbranch_vccz L_f1
  s_add_u32 s59, s59, 1
  s_cmp_lt_u32 s59, 131072
  s_cbranch_scc1 L_f0
L_f1:
  ds_write_b128 v6, v[232:235]
  s_mov_b64 exec, -1
  s_waitcnt lgkmcnt(0)
L_f2:
  s_barrier
  ds_read_b128 v[232:235], v8 offset:0
  ds_read_b128 v[236:239], v8 offset:64
  ds_read_b128 v[240:243], v8 offset:128
  ds_read_b128 v[244:247], v8 offset:192
  s_waitcnt lgkmcnt(3)
  s_nop 0
  v_mfma_f32_16x16x32_bf16 v[248:251], v[16:19], v[232:235], 0
  v_mfma_f32_16x16x32_bf16 v[252:255], v[20:23], v[232:235], 0
  ds_read_b128 v[16:19], v8 offset:256
  ds_read_b128 v[20:23], v8 offset:320
  s_waitcnt lgkmcnt(4)
  s_nop 0
  v_mfma_f32_16x16x32_bf16 v[248:251], v[24:27], v[236:239], v[248:251]
  v_mfma_f32_16x16x32_bf16 v[252:255], v[28:31], v[236:239], v[252:255]
  ds_read_b128 v[24:27], v8 offset:384
  ds_read_b128 v[28:31], v8 offset:448
  s_waitcnt lgkmcnt(5)
  s_nop 0
  v_mfma_f32_16x16x32_bf16 v[248:251], v[32:35], v[240:243], v[248:251]
  v_mfma_f32_16x16x32_bf16 v[252:255], v[36:39], v[240:243], v[252:255]
  ds_read_b128 v[32:35], v8 offset:512
  ds_read_b128 v[36:39], v8 offset:576
  s_waitcnt lgkmcnt(6)
  s_nop 0
  v_mfma_f32_16x16x32_bf16 v[248:251], v[40:43], v[244:247], v[248:251]
  v_mfma_f32_16x16x32_bf16 v[252:255], v[44:47], v[244:247], v[252:255]
  ds_read_b128 v[40:43], v8 offset:640
  ds_read_b128 v[44:47], v8 offset:704
  s_waitcnt lgkmcnt(7)
  s_nop 0
  v_mfma_f32_16x16x32_bf16 v[248:251], v[48:51], v[16:19], v[248:251]
  v_mfma_f32_16x16x32_bf16 v[252:255], v[52:55], v[16:19], v[252:255]
  ds_read_b128 v[48:51], v8 offset:768
  ds_read_b128 v[52:55], v8 offset:832
  s_waitcnt lgkmcnt(8)
  s_nop 0
  v_mfma_f32_16x16x32_bf16 v[248:251], v[56:59], v[20:23], v[248:251]
  v_mfma_f32_16x16x32_bf16 v[252:255], v[60:63], v[20:23], v[252:255]
  ds_read_b128 v[56:59], v8 offset:896
  ds_read_b128 v[60:63], v8 offset:960
  s_waitcnt lgkmcnt(9)
  s_nop 0
  v_mfma_f32_16x16x32_bf16 v[248:251], v[64:67], v[24:27], v[248:251]
  v_mfma_f32_16x16x32_bf16 v[252:255], v[68:71], v[24:27], v[252:255]
  ds_read_b128 v[64:67], v8 offset:1024
  ds_read_b128 v[68:71], v8 offset:1088
  s_waitcnt lgkmcnt(10)
  v_mfma_f32_16x16x32_bf16 v[248:251], v[72:75], v[28:31], v[248:251]
  v_mfma_f32_16x16x32_bf16 v[252:255], v[76:79], v[28:31], v[252:255]
  s_waitcnt lgkmcnt(9)
  v_mfma_f32_16x16x32_bf16 v[248:251], v[80:83], v[32:35], v[248:251]
  v_mfma_f32_16x16x32_bf16 v[252:255], v[84:87], v[32:35], v[252:255]
  s_waitcnt lgkmcnt(8)
  v_mfma_f32_16x16x32_bf16 v[248:251], v[88:91], v[36:39], v[248:251]
  v_mfma_f32_16x16x32_bf16 v[252:255], v[92:95], v[36:39], v[252:255]
  s_waitcnt lgkmcnt(7)
  v_mfma_f32_16x16x32_bf16 v[248:251], v[96:99], v[40:43], v[248:251]
  v_mfma_f32_16x16x32_bf16 v[252:255], v[100:103], v[40:43], v[252:255]
  s_waitcnt lgkmcnt(6)
  v_mfma_f32_16x16x32_bf16 v[248:251], v[104:107], v[44:47], v[248:251]
  v_mfma_f32_16x16x32_bf16 v[252:255], v[108:111], v[44:47], v[252:255]
  s_waitcnt lgkmcnt(5)
  v_mfma_f32_16x16x32_bf16 v[248:251], v[112:115], v[48:51], v[248:251]
  v_mfma_f32_16x16x32_bf16 v[252:255], v[116:119], v[48:51], v[252:255]
  s_waitcnt lgkmcnt(4)
  v_mfma_f32_16x16x32_bf16 v[248:251], v[120:123], v[52:55], v[248:251]
  v_mfma_f32_16x16x32_bf16 v[252:255], v[124:127], v[52:55], v[252:255]
  s_waitcnt lgkmcnt(3)
  v_mfma_f32_16x16x32_bf16 v[248:251], v[128:131], v[56:59], v[248:251]
  v_mfma_f32_16x16x32_bf16 v[252:255], v[132:135], v[56:59], v[252:255]
  s_waitcnt lgkmcnt(2)
  v_mfma_f32_16x16x32_bf16 v[248:251], v[136:139], v[60:63], v[248:251]
  v_mfma_f32_16x16x32_bf16 v[252:255], v[140:143], v[60:63], v[252:255]
  s_waitcnt lgkmcnt(1)
  v_mfma_f32_16x16x32_bf16 v[248:251], v[144:147], v[64:67], v[248:251]
  v_mfma_f32_16x16x32_bf16 v[252:255], v[148:151], v[64:67], v[252:255]
  s_waitcnt lgkmcnt(0)
  v_mfma_f32_16x16x32_bf16 v[248:251], v[152:155], v[68:71], v[248:251]
  v_mfma_f32_16x16x32_bf16 v[252:255], v[156:159], v[68:71], v[252:255]
  s_nop 6
  v_cndmask_b32_e64 v248, v248, v249, s[46:47]
  v_cndmask_b32_e64 v250, v250, v251, s[46:47]
  v_cndmask_b32_e64 v252, v252, v253, s[46:47]
  v_cndmask_b32_e64 v254, v254, v255, s[46:47]
  v_cndmask_b32_e64 v248, v248, v250, s[52:53]
  v_cndmask_b32_e64 v252, v252, v254, s[52:53]
  v_cndmask_b32_e64 v2, v248, v252, s[34:35]
  v_cvt_pk_bf16_f32 v2, v2, v2
  v_and_b32 v3, 0xffff0000, v2
  v_and_b32 v4, 0xffff0000, v2
  s_nop 1
  v_permlane32_swap_b32 v3, v4
  v_mul_f32 v2, 0xbfb8aa3b, v3
  v_exp_f32 v2, v2
  s_nop 0
  v_add_f32 v2, 1.0, v2
  v_rcp_f32 v2, v2
  s_nop 0
  v_mul_f32 v3, v3, v2
  v_cvt_pk_bf16_f32 v3, v3, v3
  v_and_b32 v3, 0xffff0000, v3
  v_mul_f32_e64 v3, v3, v4
  v_cvt_pk_bf16_f32 v3, v3, v3
  s_mov_b32 exec_hi, 0
  ds_write_b16 v9, v3
  s_mov_b32 exec_hi, -1
  s_waitcnt lgkmcnt(0)
  s_barrier
  ds_read_b128 v[232:235], v10
  ds_read_b128 v[236:239], v10 offset:64
  s_mov_b32 s56, 0x30003
  s_mov_b32 s57, 0x30003
  s_waitcnt lgkmcnt(0)
  s_nop 0
  v_mfma_f32_16x16x32_bf16 v[48:51], v[224:227], v[232:235], 0
  v_mfma_f32_16x16x32_bf16 v[48:51], v[228:231], v[236:239], v[48:51]
  v_mfma_f32_16x16x32_bf16 v[16:19], v[160:163], v[232:235], 0
  v_mfma_f32_16x16x32_bf16 v[16:19], v[164:167], v[236:239], v[16:19]
  v_mfma_f32_16x16x32_bf16 v[20:23], v[168:171], v[232:235], 0
  v_mfma_f32_16x16x32_bf16 v[20:23], v[172:175], v[236:239], v[20:23]
  v_mfma_f32_16x16x32_bf16 v[24:27], v[176:179], v[232:235], 0
  v_mfma_f32_16x16x32_bf16 v[24:27], v[180:183], v[236:239], v[24:27]
  v_mfma_f32_16x16x32_bf16 v[28:31], v[184:187], v[232:235], 0
  v_mfma_f32_16x16x32_bf16 v[28:31], v[188:191], v[236:239], v[28:31]
  buffer_store_dwordx4 v[48:51], v11, s[36:39], s60 offen offset:512 sc1
  v_mfma_f32_16x16x32_bf16 v[32:35], v[192:195], v[232:235], 0
  v_mfma_f32_16x16x32_bf16 v[32:35], v[196:199], v[236:239], v[32:35]
  v_mfma_f32_16x16x32_bf16 v[36:39], v[200:203], v[232:235], 0
  v_cndmask_b32_e64 v16, v16, v20, s[46:47]
  s_nop 2
  s_nop 0
  v_cndmask_b32_e64 v24, v24, v28, s[46:47]
  v_mfma_f32_16x16x32_bf16 v[36:39], v[204:207], v[236:239], v[36:39]
  v_cndmask_b32_e64 v17, v17, v21, s[46:47]
  v_cndmask_b32_e64 v25, v25, v29, s[46:47]
  v_mfma_f32_16x16x32_bf16 v[40:43], v[208:211], v[232:235], 0
  v_cndmask_b32_e64 v18, v18, v22, s[46:47]
  v_cndmask_b32_e64 v26, v26, v30, s[46:47]
  v_mfma_f32_16x16x32_bf16 v[40:43], v[212:215], v[236:239], v[40:43]
  v_cndmask_b32_e64 v19, v19, v23, s[46:47]
  v_cndmask_b32_e64 v27, v27, v31, s[46:47]
  v_mfma_f32_16x16x32_bf16 v[44:47], v[216:219], v[232:235], 0
  v_cndmask_b32_e64 v16, v16, v24, s[52:53]
  v_cndmask_b32_e64 v17, v17, v25, s[52:53]
  v_mfma_f32_16x16x32_bf16 v[44:47], v[220:223], v[236:239], v[44:47]
  v_cndmask_b32_e64 v18, v18, v26, s[52:53]
  v_cndmask_b32_e64 v19, v19, v27, s[52:53]
  buffer_store_dwordx4 v[16:19], v15, s[36:39], s60 offen offset:0 sc1
  v_cndmask_b32_e64 v32, v32, v36, s[46:47]
  s_nop 3
  s_nop 0
  v_cndmask_b32_e64 v40, v40, v44, s[46:47]
  v_cndmask_b32_e64 v33, v33, v37, s[46:47]
  v_cndmask_b32_e64 v41, v41, v45, s[46:47]
  v_cndmask_b32_e64 v34, v34, v38, s[46:47]
  v_cndmask_b32_e64 v42, v42, v46, s[46:47]
  v_cndmask_b32_e64 v35, v35, v39, s[46:47]
  v_cndmask_b32_e64 v43, v43, v47, s[46:47]
  v_cndmask_b32_e64 v32, v32, v40, s[52:53]
  v_cndmask_b32_e64 v33, v33, v41, s[52:53]
  v_cndmask_b32_e64 v34, v34, v42, s[52:53]
  v_cndmask_b32_e64 v35, v35, v43, s[52:53]
  buffer_store_dwordx4 v[32:35], v15, s[36:39], s60 offen offset:256 sc1
  s_waitcnt vmcnt(2)
  s_barrier
L_fin:
  s_endpgm
L_fz:
  v_readfirstlane_b32 s50, v236
  v_readfirstlane_b32 s51, v237
  v_readfirstlane_b32 s61, v2
  v_readfirstlane_b32 s62, v3
  s_cmp_ge_u32 s49, 18
  s_cselect_b32 s50, s51, s50
  s_cselect_b32 s61, s62, s61
  s_cselect_b32 s56, 18, 0
  s_mul_i32 s61, s61, 2304
  s_andn2_b32 s52, 0x7ff, s50
  s_sub_u32 s56, s49, s56
  s_lshl_b32 s56, s56, 6
  s_add_u32 s61, s61, s56
  s_add_u32 s61, s61, 3067904
  s_mul_i32 s52, s52, 1152
  s_add_u32 s52, s52, s56
  s_lshl_b32 s62, s49, 7
  s_add_u32 s62, s62, 3141632
  v_and_b32 v2, 7, v1
  v_lshlrev_b32 v4, 3, v2
  v_lshrrev_b32_e64 v3, 3, v1
  v_mul_u32_u24 v3, 4608, v3
  v_lshl_add_u32 v3, v2, 4, v3
  s_ashr_i32 s56, s50, 31
  s_not_b32 s56, s56
  s_or_b32 s56, s56, 0x80000000
  s_xor_b32 s56, s56, s50
  s_and_b32 s56, s56, 0xffff0000
  v_mov_b32 v5, 0xbfb8aa3b
  v_mul_f32 v5, s56, v5
  v_exp_f32 v5, v5
  s_nop 0
  v_add_f32 v5, 1.0, v5
  v_rcp_f32_e64 v5, v5
  s_nop 0
  v_cvt_pk_bf16_f32 v5, v5, v5
  v_and_b32 v5, 0xffff0000, v5
  s_mov_b32 s59, 0
  s_mov_b32 s68, s20
  s_mov_b32 s69, s21
  s_mov_b32 s70, 2359296
  s_mov_b32 s71, 0x20000
  s_barrier
  s_barrier
L_h0:
  buffer_load_dwordx2 v[52:53], v4, s[36:39], s61 offen sc1
  buffer_load_dwordx2 v[54:55], v4, s[36:39], s61 offen offset:1152 sc1
  s_waitcnt vmcnt(0)
  v_max3_u32 v2, v52, v53, v54
  v_max_u32 v2, v2, v55
  v_cmp_eq_u32 vcc, -1, v2
  s_cbranch_vccz L_h1
  s_add_u32 s59, s59, 1
  s_cmp_lt_u32 s59, 131072
  s_cbranch_scc1 L_h0
L_h1:
  v_lshlrev_b32 v56, 16, v52
  v_and_b32 v57, 0xffff0000, v52
  v_lshlrev_b32_e64 v58, 16, v53
  v_and_b32 v59, 0xffff0000, v53
  v_lshlrev_b32_e64 v60, 16, v54
  v_and_b32 v61, 0xffff0000, v54
  v_lshlrev_b32_e64 v62, 16, v55
  v_and_b32 v63, 0xffff0000, v55
  s_mov_b32 s59, -1
L_d2:
  s_nop 0
  v_max3_u32 v2, v16, v17, v18
  v_max3_u32 v2, v2, v19, v20
  v_max3_u32 v2, v2, v21, v22
  v_max3_u32 v2, v2, v23, v24
  v_max3_u32 v2, v2, v25, v26
  v_max3_u32 v2, v2, v27, v28
  v_max3_u32 v2, v2, v29, v30
  v_max3_u32 v2, v2, v31, v32
  v_max3_u32 v2, v2, v33, v34
  v_max3_u32 v2, v2, v35, v36
  v_max3_u32 v2, v2, v37, v38
  v_max3_u32 v2, v2, v39, v40
  v_max3_u32 v2, v2, v41, v42
  v_max3_u32 v2, v2, v43, v44
  v_max3_u32 v2, v2, v45, v46
  v_max3_u32 v2, v2, v47, v48
  v_max3_u32 v2, v2, v49, v50
  v_max_u32 v2, v2, v51
  v_cmp_eq_u32_e64 vcc, -1, v2
  s_add_u32 s59, s59, 1
  s_cbranch_scc1 L_dw
  s_cbranch_vccz L_d1
  s_cmp_ge_u32 s59, 131072
  s_cbranch_scc1 L_d1
  s_branch L_d0
L_dw:
  s_barrier
L_d0:
  s_mov_b32 s57, s62
  buffer_load_dwordx4 v[16:19], v3, s[36:39], s57 offen sc1
  s_add_u32 s57, s57, 36864
  buffer_load_dwordx4 v[20:23], v3, s[36:39], s57 offen sc1
  s_add_u32 s57, s57, 36864
  buffer_load_dwordx4 v[24:27], v3, s[36:39], s57 offen sc1
  s_add_u32 s57, s57, 36864
  buffer_load_dwordx4 v[28:31], v3, s[36:39], s57 offen sc1
  s_add_u32 s57, s57, 36864
  buffer_load_dwordx4 v[32:35], v3, s[36:39], s57 offen sc1
  s_add_u32 s57, s57, 36864
  buffer_load_dwordx4 v[36:39], v3, s[36:39], s57 offen sc1
  s_add_u32 s57, s57, 36864
  buffer_load_dwordx4 v[40:43], v3, s[36:39], s57 offen sc1
  s_add_u32 s57, s57, 36864
  buffer_load_dwordx4 v[44:47], v3, s[36:39], s57 offen sc1
  s_add_u32 s57, s57, 36864
  buffer_load_dwordx4 v[48:51], v3, s[36:39], s57 offen sc1
  s_waitcnt vmcnt(7)
  v_pk_add_f32 v[8:9], v[16:17], v[20:21]
  v_pk_add_f32 v[10:11], v[18:19], v[22:23]
  s_waitcnt vmcnt(6)
  v_pk_add_f32 v[8:9], v[8:9], v[24:25]
  v_pk_add_f32 v[10:11], v[10:11], v[26:27]
  s_waitcnt vmcnt(5)
  v_pk_add_f32 v[8:9], v[8:9], v[28:29]
  v_pk_add_f32 v[10:11], v[10:11], v[30:31]
  s_waitcnt vmcnt(4)
  v_pk_add_f32 v[8:9], v[8:9], v[32:33]
  v_pk_add_f32 v[10:11], v[10:11], v[34:35]
  s_waitcnt vmcnt(3)
  v_pk_add_f32 v[8:9], v[8:9], v[36:37]
  v_pk_add_f32 v[10:11], v[10:11], v[38:39]
  s_waitcnt vmcnt(2)
  v_pk_add_f32 v[8:9], v[8:9], v[40:41]
  v_pk_add_f32 v[10:11], v[10:11], v[42:43]
  s_waitcnt vmcnt(1)
  v_pk_add_f32 v[8:9], v[8:9], v[44:45]
  v_pk_add_f32 v[10:11], v[10:11], v[46:47]
  s_waitcnt vmcnt(0)
  v_pk_add_f32 v[8:9], v[8:9], v[48:49]
  v_pk_add_f32 v[10:11], v[10:11], v[50:51]
  v_pk_add_f32 v[6:7], v[8:9], v[10:11]
  v_cmp_u_f32 vcc, v6, v7
  s_cbranch_vccnz L_d2
L_d1:
  v_add_f32_dpp v16, v8, v8 row_ror:8 row_mask:0xf bank_mask:0xf
  v_add_f32_dpp v20, v8, v8 row_ror:8 row_mask:0xf bank_mask:0xf
  v_add_f32_dpp v17, v9, v9 row_ror:8 row_mask:0xf bank_mask:0xf
  v_add_f32_dpp v21, v9, v9 row_ror:8 row_mask:0xf bank_mask:0xf
  v_add_f32_dpp v18, v10, v10 row_ror:8 row_mask:0xf bank_mask:0xf
  v_add_f32_dpp v22, v10, v10 row_ror:8 row_mask:0xf bank_mask:0xf
  v_add_f32_dpp v19, v11, v11 row_ror:8 row_mask:0xf bank_mask:0xf
  v_add_f32_dpp v23, v11, v11 row_ror:8 row_mask:0xf bank_mask:0xf
  v_permlane16_swap_b32 v16, v20
  v_permlane16_swap_b32 v17, v21
  v_permlane16_swap_b32 v18, v22
  v_permlane16_swap_b32 v19, v23
  v_pk_add_f32 v[24:25], v[16:17], v[20:21]
  v_pk_add_f32 v[16:17], v[16:17], v[20:21]
  v_pk_add_f32 v[26:27], v[18:19], v[22:23]
  v_pk_add_f32 v[18:19], v[18:19], v[22:23]
  v_permlane32_swap_b32 v16, v24
  v_permlane32_swap_b32 v17, v25
  v_permlane32_swap_b32 v18, v26
  v_permlane32_swap_b32 v19, v27
  v_pk_add_f32 v[16:17], v[16:17], v[24:25]
  v_pk_add_f32 v[18:19], v[18:19], v[26:27]
  v_cvt_pk_bf16_f32 v24, v16, v17
  v_cvt_pk_bf16_f32 v25, v18, v19
  v_lshlrev_b32_e64 v16, 16, v24
  v_and_b32 v17, 0xffff0000, v24
  v_lshlrev_b32_e64 v18, 16, v25
  v_and_b32 v19, 0xffff0000, v25
  v_mul_f32 v16, v16, v5
  v_mul_f32 v17, v17, v5
  v_mul_f32 v18, v18, v5
  v_mul_f32 v19, v19, v5
  v_cvt_pk_bf16_f32 v24, v16, v17
  v_cvt_pk_bf16_f32 v25, v18, v19
  v_lshlrev_b32_e64 v16, 16, v24
  v_and_b32 v17, 0xffff0000, v24
  v_lshlrev_b32_e64 v18, 16, v25
  v_and_b32 v19, 0xffff0000, v25
  v_pk_add_f32 v[16:17], v[16:17], v[56:57]
  v_pk_add_f32 v[18:19], v[18:19], v[58:59]
  v_cvt_pk_bf16_f32 v24, v16, v17
  v_cvt_pk_bf16_f32 v25, v18, v19
  v_lshlrev_b32_e64 v16, 16, v24
  v_and_b32 v17, 0xffff0000, v24
  v_lshlrev_b32_e64 v18, 16, v25
  v_and_b32 v19, 0xffff0000, v25
  v_pk_add_f32 v[16:17], v[16:17], v[60:61]
  v_pk_add_f32 v[18:19], v[18:19], v[62:63]
  v_cvt_pk_bf16_f32 v24, v16, v17
  v_cvt_pk_bf16_f32 v25, v18, v19
  s_mov_b64 exec, 0xff
  buffer_store_dwordx2 v[24:25], v4, s[68:71], s52 offen sc1
  s_endpgm
L_end:
  s_endpgm
  s_endpgm
  s_endpgm
  s_endpgm
  s_endpgm
  s_endpgm
  s_endpgm
  s_endpgm
  s_endpgm
  s_endpgm
  s_endpgm
  s_endpgm
  s_endpgm
  s_endpgm
  s_endpgm
  s_endpgm
  s_endpgm
  s_endpgm
  s_endpgm
  s_endpgm
  s_endpgm
  s_endpgm
  s_endpgm
  s_endpgm
  s_endpgm
  s_endpgm
  s_endpgm
  s_endpgm
  s_endpgm
  s_endpgm
  s_endpgm
  s_endpgm
  s_endpgm
  s_endpgm
  s_endpgm
  s_endpgm
  s_endpgm
  s_endpgm
  s_endpgm
  s_endpgm
  s_endpgm
  s_endpgm
  s_endpgm
  s_endpgm
  s_endpgm
  s_endpgm
  s_endpgm
  s_endpgm
  s_endpgm
  s_endpgm
  s_endpgm
  s_endpgm
  s_endpgm
  s_endpgm
  s_endpgm
  s_endpgm
  s_endpgm
  s_endpgm
  s_endpgm
  s_endpgm
  s_endpgm
  s_endpgm
  s_endpgm
  s_endpgm
  s_endpgm
  s_endpgm
  s_endpgm
  s_endpgm
  s_endpgm
  s_endpgm
  s_endpgm
  s_endpgm
  s_endpgm
  s_endpgm
  s_endpgm
  s_endpgm
  s_endpgm
  s_endpgm
  s_endpgm
  s_endpgm
  s_endpgm
  s_endpgm
  s_endpgm
  s_endpgm
  s_endpgm
  s_endpgm
  s_endpgm
  s_endpgm
  s_endpgm
  s_endpgm
  s_endpgm
  s_endpgm
  s_endpgm
  s_endpgm
  s_endpgm
  s_endpgm
  s_endpgm
L_codeend:

.section .rodata,"a"
.p2align 6
.amdhsa_kernel sequential_preLN__linear_attn_block__moe_arch_mod__prompt_kernel
  .amdhsa_next_free_vgpr 256
  .amdhsa_next_free_sgpr 102
  .amdhsa_accum_offset 256
  .amdhsa_group_segment_fixed_size 0
  .amdhsa_kernarg_size 88
  .amdhsa_user_sgpr_count 2
  .amdhsa_user_sgpr_kernarg_segment_ptr 1
  .amdhsa_system_sgpr_workgroup_id_x 1
.end_amdhsa_kernel
```
